```python
import torch

def _softmax(x, axis=-1):
    return torch.softmax(x, dim=axis)
def _gelu(x):
    return torch.nn.functional.gelu(x, approximate="tanh")
def _silu(x):
    return torch.nn.functional.silu(x)
def _sigmoid(x):
    return torch.sigmoid(x)
def _layernorm(x, axis=-1, eps=1e-5):
    m = x.mean(dim=axis, keepdim=True)
    v = x.var(dim=axis, keepdim=True, unbiased=False)
    return (x - m) / torch.sqrt(v + eps)
def _scatter_add(tgt, idx, src, axis=0):
    return tgt.clone().index_add_(axis, idx, src)
def _segment_sum(src, seg, n):
    out = torch.zeros((n,) + src.shape[1:], dtype=src.dtype)
    return out.index_add_(0, seg, src)
def _pad(x, pw):
    flat = tuple(v for pair in reversed(pw) for v in pair)
    return torch.nn.functional.pad(x, flat)

kernel_name = 'sequential_preLN__mha_block_cached__glu_gated_reglu__decode'

def setup_inputs():

    _w = (lambda a: (lambda t: t.to(torch.bfloat16) if t.is_floating_point() else t)(torch.as_tensor(a)))
    def _A_setup():
        B, Sq, D = 8, 1, 512
        H, Sk, Dh = 32, 4096, 128
        return {
            "x": _w((lambda *s: torch.randn(*s, dtype=torch.bfloat16) * 0.05)(B, Sq, D)),
            "k_cache": _w((lambda *s: torch.randn(*s, dtype=torch.bfloat16) * 1.6)(B, H, Sk, Dh)),
            "v_cache": _w((lambda *s: torch.randn(*s, dtype=torch.bfloat16) * 0.8)(B, H, Sk, Dh)),
            "wq": _w((lambda *s: torch.randn(*s, dtype=torch.bfloat16) * 1.6)(D, H * Dh) * (D ** -0.5)),
            "wo": _w((lambda *s: torch.randn(*s, dtype=torch.bfloat16) * 0.8)(H * Dh, D) * ((H * Dh) ** -0.5)),
        }
    _A_in = _A_setup()

    def _B_setup():
        B, S, D, F = 8, 1, 512, 1792
        return {
            "x": _w((lambda *s: torch.randn(*s, dtype=torch.bfloat16) * 0.05)(B, S, D)),
            "W_gate": _w((lambda *s: torch.randn(*s, dtype=torch.bfloat16) * 0.4)(D, F) * (2.0 / D) ** 0.5),
            "W_up": _w((lambda *s: torch.randn(*s, dtype=torch.bfloat16) * 0.4)(D, F) * (2.0 / D) ** 0.5),
            "W_down": _w((lambda *s: torch.randn(*s, dtype=torch.bfloat16) * 0.4)(F, D) * (1.0 / F) ** 0.5),
        }
    _B_in = _B_setup()

    return {
        "A_x": _A_in["x"],
        "A_k_cache": _A_in["k_cache"],
        "A_v_cache": _A_in["v_cache"],
        "A_wq": _A_in["wq"],
        "A_wo": _A_in["wo"],
        "B_x": _B_in["x"],
        "B_W_gate": _B_in["W_gate"],
        "B_W_up": _B_in["W_up"],
        "B_W_down": _B_in["W_down"],
    }

def reference(A_x, A_k_cache, A_v_cache, A_wq, A_wo, B_x, B_W_gate, B_W_up, B_W_down):
    def _A_ref(x, k_cache, v_cache, wq, wo):
        B, Sq, D = x.shape
        H, Dh = 32, 128
        q = (lambda x, *d: x.permute(*d))((x @ wq).reshape(B, Sq, H, Dh), 0, 2, 1, 3)
        scores = torch.einsum("bhqd,bhkd->bhqk", q, k_cache) * (Dh ** -0.5)
        p = _softmax(scores, axis=-1)
        o = torch.einsum("bhqk,bhkd->bhqd", p, v_cache)
        return (lambda x, *d: x.permute(*d))(o, 0, 2, 1, 3).reshape(B, Sq, H * Dh) @ wo

    def _B_ref(x, W_gate, W_up, W_down):
        gate = torch.einsum("bsd,df->bsf", x, W_gate)
        up = torch.einsum("bsd,df->bsf", x, W_up)
        gate = gate * (lambda x, dt: x.to(dt))(gate > 0, gate.dtype)
        h = gate * up
        return torch.einsum("bsf,fd->bsd", h, W_down)

    x = A_x
    h = x + _A_ref(_layernorm(x, axis=-1), A_k_cache, A_v_cache, A_wq, A_wo)
    h2 = h + _B_ref(_layernorm(h, axis=-1), B_W_gate, B_W_up, B_W_down)
    return h2
```

```asm
; @launch grid=(256,1,1) block=(256,1,1) lds=106496
.amdgcn_target "amdgcn-amd-amdhsa--gfx950"
.text
.globl sequential_preLN__mha_block_cached__glu_gated_reglu__decode_kernel
.p2align 8
.type sequential_preLN__mha_block_cached__glu_gated_reglu__decode_kernel,@function
sequential_preLN__mha_block_cached__glu_gated_reglu__decode_kernel:
    s_cmp_ge_u32 s2, 256
    s_cbranch_scc1 L_end
    s_memrealtime s[18:19]
    s_load_dwordx16 s[64:79], s[0:1], 0
    s_load_dwordx8 s[80:87], s[0:1], 64
    s_getpc_b64 s[60:61]
    s_and_b32 s60, s60, 0xffffff00
    s_lshr_b32 s58, s2, 3
    s_lshl_b32 s58, s58, 8
    v_add_u32 v60, s58, v0
    v_lshlrev_b32 v60, 4, v60
    v_cmp_gt_u32 vcc, 23552, v60
    s_nop 0
    s_and_saveexec_b64 s[62:63], vcc
    s_cbranch_execz L_nocpf
    global_load_dwordx4 v[76:79], v60, s[60:61]
L_nocpf:
    s_mov_b64 exec, -1
    v_lshrrev_b32 v1, 6, v0
    s_nop 0
    v_readfirstlane_b32 s3, v1
    v_and_b32 v1, 63, v0
    s_lshr_b32 s4, s2, 5
    s_and_b32 s5, s2, 31
    s_mov_b32 s5, 0
    s_bfe_u32 s58, s2, 0x10000
    s_lshl_b32 s58, s58, 0
    s_or_b32 s5, s5, s58
    s_bfe_u32 s58, s2, 0x10001
    s_lshl_b32 s58, s58, 2
    s_or_b32 s5, s5, s58
    s_bfe_u32 s58, s2, 0x10002
    s_lshl_b32 s58, s58, 3
    s_or_b32 s5, s5, s58
    s_bfe_u32 s58, s2, 0x10003
    s_lshl_b32 s58, s58, 1
    s_or_b32 s5, s5, s58
    s_bfe_u32 s58, s2, 0x10004
    s_lshl_b32 s58, s58, 4
    s_or_b32 s5, s5, s58
    v_lshrrev_b32 v74, 4, v1
    v_and_b32 v75, 15, v1
    v_lshlrev_b32 v48, 4, v1
    s_lshl_b32 s58, s3, 12
    v_add_u32 v2, s58, v48
    v_add_u32 v3, 16384, v2
    v_add_u32 v4, 32768, v2
    v_add_u32 v5, 49152, v2
    v_add_u32 v6, 65536, v2
    v_add_u32 v7, 81920, v2
    v_add_u32 v8, 98304, v2
    v_add_u32 v9, 114688, v2
    s_lshl_b32 s58, s3, 8
    v_lshlrev_b32 v49, 3, v75
    v_lshl_add_u32 v49, v74, 1, v49
    v_add_u32 v49, s58, v49
    v_lshrrev_b32 v51, 1, v74
    s_lshl_b32 s58, s3, 20
    v_lshlrev_b32 v58, 13, v74
    v_lshl_add_u32 v58, v75, 4, v58
    v_add_u32 v58, s58, v58
    s_lshl_b32 s58, s3, 8
    v_lshlrev_b32 v59, 10, v74
    v_lshl_add_u32 v59, v75, 4, v59
    v_add_u32 v59, s58, v59
    s_lshl_b32 s57, s4, 10
    s_lshl_b32 s58, s5, 8
    s_lshl_b32 s59, s4, 5
    s_add_u32 s59, s59, s5
    s_lshl_b32 s59, s59, 20
    s_sub_u32 s92, 0x400000, s58
    s_mov_b32 s54, 0
    s_waitcnt lgkmcnt(0)
    s_add_u32 s8, s66, s59
    s_addc_u32 s9, s67, 0
    s_mov_b32 s10, 1048576
    s_mov_b32 s11, 0x20000
    buffer_load_dwordx4 v[128:131], v2, s[8:11], s54 offen offset:0 nt
    s_mov_b32 s28, s64
    s_mov_b32 s29, s65
    s_mov_b32 s30, 8192
    s_mov_b32 s31, 0x20000
    buffer_load_dwordx4 v[52:55], v48, s[28:31], s57 offen
    buffer_load_ushort v56, v49, s[28:31], s57 offen
    buffer_load_ushort v57, v49, s[28:31], s57 offen offset:128
    s_add_u32 s20, s70, s58
    s_addc_u32 s21, s71, 0
    s_mov_b32 s22, s92
    s_mov_b32 s23, 0x20000
    s_mov_b32 s58, 0
    buffer_load_dwordx4 a[0:3], v58, s[20:23], s58 offen
    s_mov_b32 s58, 32768
    buffer_load_dwordx4 a[4:7], v58, s[20:23], s58 offen
    buffer_load_dwordx4 v[132:135], v2, s[8:11], s54 offen offset:1024 nt
    s_mov_b32 s58, 65536
    buffer_load_dwordx4 a[8:11], v58, s[20:23], s58 offen
    s_mov_b32 s58, 98304
    buffer_load_dwordx4 a[12:15], v58, s[20:23], s58 offen
    buffer_load_dwordx4 v[136:139], v2, s[8:11], s54 offen offset:2048 nt
    s_mov_b32 s58, 131072
    buffer_load_dwordx4 a[16:19], v58, s[20:23], s58 offen
    s_mov_b32 s58, 163840
    buffer_load_dwordx4 a[20:23], v58, s[20:23], s58 offen
    buffer_load_dwordx4 v[140:143], v2, s[8:11], s54 offen offset:3072 nt
    s_mov_b32 s58, 196608
    buffer_load_dwordx4 a[24:27], v58, s[20:23], s58 offen
    s_mov_b32 s58, 229376
    buffer_load_dwordx4 a[28:31], v58, s[20:23], s58 offen
    buffer_load_dwordx4 v[144:147], v3, s[8:11], s54 offen offset:0 nt
    s_mov_b32 s58, 262144
    buffer_load_dwordx4 a[32:35], v58, s[20:23], s58 offen
    s_mov_b32 s58, 294912
    buffer_load_dwordx4 a[36:39], v58, s[20:23], s58 offen
    buffer_load_dwordx4 v[148:151], v3, s[8:11], s54 offen offset:1024 nt
    s_mov_b32 s58, 327680
    buffer_load_dwordx4 a[40:43], v58, s[20:23], s58 offen
    s_mov_b32 s58, 360448
    buffer_load_dwordx4 a[44:47], v58, s[20:23], s58 offen
    buffer_load_dwordx4 v[152:155], v3, s[8:11], s54 offen offset:2048 nt
    s_mov_b32 s58, 393216
    buffer_load_dwordx4 a[48:51], v58, s[20:23], s58 offen
    s_mov_b32 s58, 425984
    buffer_load_dwordx4 a[52:55], v58, s[20:23], s58 offen
    s_add_u32 s16, s68, s59
    s_addc_u32 s17, s69, 0
    s_mov_b32 s12, s8
    s_mov_b32 s13, s9
    s_mov_b32 s14, 0x100000
    s_mov_b32 s15, 0x20000
    s_lshl_b32 s58, s5, 17
    s_add_u32 s24, s72, s58
    s_addc_u32 s25, s73, 0
    s_mov_b32 s26, 131072
    s_mov_b32 s27, 0x20000
    s_mov_b32 s32, s86
    s_mov_b32 s33, s87
    s_mov_b32 s34, 1310720
    s_mov_b32 s35, 0x20000
    s_mov_b32 s36, s82
    s_mov_b32 s37, s83
    s_mov_b32 s38, 8192
    s_mov_b32 s39, 0x20000
    s_mov_b32 s40, s76
    s_mov_b32 s41, s77
    s_mov_b32 s42, 1835008
    s_mov_b32 s43, 0x20000
    s_mov_b32 s44, s78
    s_mov_b32 s45, s79
    s_mov_b32 s46, 1835008
    s_mov_b32 s47, 0x20000
    s_and_b32 s58, s2, 7
    s_lshr_b32 s92, s2, 3
    s_mul_i32 s89, s58, 7
    s_add_u32 s89, s89, s92
    s_cmp_lt_u32 s2, 56
    s_cselect_b32 s7, 1, 0
    s_lshl_b32 s58, s58, 2
    s_add_u32 s58, s58, s92
    s_sub_u32 s58, s58, 28
    s_cmp_ge_u32 s2, 224
    s_cselect_b32 s89, s58, s89
    s_cselect_b32 s7, 3, s7
    s_sub_u32 s58, s2, 64
    s_cmp_lt_u32 s58, 64
    s_cselect_b32 s89, s58, s89
    s_cselect_b32 s7, 2, s7
    s_lshl_b32 s6, s3, 2
    s_add_u32 s6, s6, s7
    v_lshrrev_b32 v68, 2, v75
    v_lshlrev_b32 v68, 15, v68
    v_lshl_add_u32 v68, v74, 4, v68
    v_and_b32 v60, 3, v75
    v_lshl_add_u32 v68, v60, 5, v68
    s_lshl_b32 s58, s3, 17
    s_lshr_b32 s92, s4, 1
    s_lshl_b32 s92, s92, 13
    s_add_u32 s58, s58, s92
    s_lshl_b32 s92, s5, 8
    s_add_u32 s58, s58, s92
    s_and_b32 s92, s4, 1
    s_lshl_b32 s92, s92, 7
    s_add_u32 s58, s58, s92
    v_add_u32 v68, s58, v68
    v_lshlrev_b32 v69, 3, v75
    v_lshl_add_u32 v69, v51, 2, v69
    v_lshrrev_b32 v50, 3, v75
    v_lshlrev_b32 v50, 10, v50
    v_and_b32 v60, 7, v75
    v_lshl_add_u32 v50, v60, 3, v50
    v_lshl_add_u32 v50, v51, 2, v50
    s_and_b32 s58, s89, 3
    s_lshl_b32 s58, s58, 11
    s_lshr_b32 s92, s89, 2
    s_lshl_b32 s92, s92, 6
    s_add_u32 s58, s58, s92
    v_add_u32 v50, s58, v50
    s_lshl_b32 s58, s89, 7
    s_add_u32 s58, s58, 524288
    v_add_u32 v69, s58, v69
    buffer_load_dword v71, v50, s[28:31], 0 offen
    v_lshlrev_b32 v70, 4, v75
    v_lshl_add_u32 v70, v74, 3, v70
    s_lshl_b32 s58, s89, 2
    s_add_u32 s58, s58, s3
    s_lshl_b32 s58, s58, 7
    s_add_u32 s58, s58, 532480
    v_add_u32 v70, s58, v70
    s_cmp_eq_u32 s7, 2
    s_cbranch_scc0 L_noclr
    v_mov_b32 v60, -1
    v_mov_b32 v61, -1
    v_mov_b32 v62, -1
    v_mov_b32 v63, -1
    s_lshl_b32 s58, s89, 13
    s_lshl_b32 s92, s3, 11
    s_add_u32 s58, s58, s92
    buffer_store_dwordx4 v[60:63], v48, s[32:35], s58 offen sc1
    buffer_store_dwordx4 v[60:63], v48, s[32:35], s58 offen offset:1024 sc1
    s_mov_b64 exec, 0x00ff00ff
    buffer_store_dwordx2 v[60:61], v70, s[32:35], 0 offen sc1
    s_cmp_eq_u32 s3, 0
    s_cbranch_scc0 L_noclr
    s_mov_b32 exec_lo, 0xffff
    s_mov_b32 exec_hi, 0xffff
    buffer_store_dword v60, v69, s[32:35], 0 offen sc1
L_noclr:
    s_mov_b64 exec, -1
    buffer_load_dwordx4 v[156:159], v3, s[8:11], s54 offen offset:3072 nt
    buffer_load_dwordx4 v[160:163], v4, s[8:11], s54 offen offset:0 nt
    buffer_load_dwordx4 v[164:167], v4, s[8:11], s54 offen offset:1024 nt
    s_mov_b32 s60, 0xcccccccc
    s_mov_b32 s61, 0xcccccccc
    s_mov_b32 s62, 0xaaaaaaaa
    s_mov_b32 s63, 0xaaaaaaaa
    s_mov_b32 s90, 0x3db504f3
    s_mov_b32 s91, 0x3fb8aa3b
    v_and_b32 v60, 1, v75
    v_lshlrev_b32 v60, 4, v60
    v_mov_b32 v61, 0xffff
    v_lshlrev_b32 v60, v60, v61
    v_lshrrev_b32 v61, 1, v75
    v_cmp_eq_u32 vcc, 0, v61
    s_nop 1
    v_cndmask_b32 v14, 0, v60, vcc
    v_cmp_eq_u32 vcc, 1, v61
    s_nop 1
    v_cndmask_b32 v15, 0, v60, vcc
    v_cmp_eq_u32 vcc, 2, v61
    s_nop 1
    v_cndmask_b32 v16, 0, v60, vcc
    v_cmp_eq_u32 vcc, 3, v61
    s_nop 1
    v_cndmask_b32 v17, 0, v60, vcc
    s_waitcnt vmcnt(26)
    buffer_load_dwordx4 v[168:171], v4, s[8:11], s54 offen offset:2048 nt
    buffer_load_dwordx4 v[172:175], v4, s[8:11], s54 offen offset:3072 nt
    buffer_load_dwordx4 v[176:179], v5, s[8:11], s54 offen offset:0 nt
    v_lshlrev_b32 v76, 16, v52
    v_and_b32 v77, 0xffff0000, v52
    v_lshlrev_b32 v78, 16, v53
    v_and_b32 v79, 0xffff0000, v53
    v_lshlrev_b32 v80, 16, v54
    v_and_b32 v81, 0xffff0000, v54
    v_lshlrev_b32 v82, 16, v55
    v_and_b32 v83, 0xffff0000, v55
    v_add_f32 v84, v76, v77
    v_add_f32 v84, v84, v78
    v_add_f32 v84, v84, v79
    v_add_f32 v84, v84, v80
    v_add_f32 v84, v84, v81
    v_add_f32 v84, v84, v82
    v_add_f32 v84, v84, v83
    s_nop 1
    v_add_f32_dpp v84, v84, v84 row_ror:8 row_mask:0xf bank_mask:0xf
    s_nop 1
    v_add_f32_dpp v84, v84, v84 row_ror:4 row_mask:0xf bank_mask:0xf
    s_nop 1
    v_add_f32_dpp v84, v84, v84 row_ror:2 row_mask:0xf bank_mask:0xf
    s_nop 1
    v_add_f32_dpp v84, v84, v84 row_ror:1 row_mask:0xf bank_mask:0xf
    v_mov_b32 v85, v84
    s_nop 1
    v_permlane16_swap_b32 v84, v85
    v_add_f32 v84, v84, v85
    v_mov_b32 v85, v84
    s_nop 1
    v_permlane32_swap_b32 v84, v85
    v_add_f32 v84, v84, v85
    v_mul_f32 v84, 0x3b000000, v84
    v_sub_f32 v76, v76, v84
    v_sub_f32 v77, v77, v84
    v_sub_f32 v78, v78, v84
    v_sub_f32 v79, v79, v84
    v_sub_f32 v80, v80, v84
    v_sub_f32 v81, v81, v84
    v_sub_f32 v82, v82, v84
    v_sub_f32 v83, v83, v84
    v_mul_f32 v86, v76, v76
    v_fmac_f32 v86, v77, v77
    v_fmac_f32 v86, v78, v78
    v_fmac_f32 v86, v79, v79
    v_fmac_f32 v86, v80, v80
    v_fmac_f32 v86, v81, v81
    v_fmac_f32 v86, v82, v82
    v_fmac_f32 v86, v83, v83
    s_nop 1
    v_add_f32_dpp v86, v86, v86 row_ror:8 row_mask:0xf bank_mask:0xf
    s_nop 1
    v_add_f32_dpp v86, v86, v86 row_ror:4 row_mask:0xf bank_mask:0xf
    s_nop 1
    v_add_f32_dpp v86, v86, v86 row_ror:2 row_mask:0xf bank_mask:0xf
    s_nop 1
    v_add_f32_dpp v86, v86, v86 row_ror:1 row_mask:0xf bank_mask:0xf
    v_mov_b32 v85, v86
    s_nop 1
    v_permlane16_swap_b32 v86, v85
    v_add_f32 v86, v86, v85
    v_mov_b32 v85, v86
    s_nop 1
    v_permlane32_swap_b32 v86, v85
    v_add_f32 v86, v86, v85
    v_mul_f32 v86, 0x3b000000, v86
    v_cvt_pk_bf16_f32 v84, v84, v84
    v_and_b32 v84, 0xffff0000, v84
    v_cvt_pk_bf16_f32 v86, v86, v86
    v_and_b32 v86, 0xffff0000, v86
    v_add_f32 v86, 0x3727c5ac, v86
    v_cvt_pk_bf16_f32 v86, v86, v86
    v_and_b32 v86, 0xffff0000, v86
    v_sqrt_f32 v86, v86
    s_nop 0
    v_cvt_pk_bf16_f32 v86, v86, v86
    v_and_b32 v86, 0xffff0000, v86
    v_rcp_f32 v86, v86
    s_waitcnt vmcnt(27)
    v_lshlrev_b32 v56, 16, v56
    v_sub_f32 v56, v56, v84
    v_cvt_pk_bf16_f32 v56, v56, v56
    v_and_b32 v56, 0xffff0000, v56
    v_mul_f32 v56, v56, v86
    v_cvt_pk_bf16_f32 v66, v56, v56
    v_lshlrev_b32 v57, 16, v57
    v_sub_f32 v57, v57, v84
    v_cvt_pk_bf16_f32 v57, v57, v57
    v_and_b32 v57, 0xffff0000, v57
    v_mul_f32 v57, v57, v86
    v_cvt_pk_bf16_f32 v67, v57, v57
    v_and_b32_dpp v18, v66, v14 row_newbcast:0 row_mask:0xf bank_mask:0xf
    v_and_b32_dpp v19, v66, v15 row_newbcast:0 row_mask:0xf bank_mask:0xf
    v_and_b32_dpp v20, v66, v16 row_newbcast:0 row_mask:0xf bank_mask:0xf
    v_and_b32_dpp v21, v66, v17 row_newbcast:0 row_mask:0xf bank_mask:0xf
    s_waitcnt vmcnt(26)
    s_nop 0
    v_mfma_f32_16x16x32_bf16 v[28:31], v[18:21], a[0:3], 0
    s_mov_b32 s58, 458752
    buffer_load_dwordx4 a[56:59], v58, s[20:23], s58 offen
    v_and_b32_dpp v22, v66, v14 row_newbcast:1 row_mask:0xf bank_mask:0xf
    v_and_b32_dpp v23, v66, v15 row_newbcast:1 row_mask:0xf bank_mask:0xf
    v_and_b32_dpp v24, v66, v16 row_newbcast:1 row_mask:0xf bank_mask:0xf
    v_and_b32_dpp v25, v66, v17 row_newbcast:1 row_mask:0xf bank_mask:0xf
    s_waitcnt vmcnt(26)
    s_nop 0
    v_mfma_f32_16x16x32_bf16 v[28:31], v[22:25], a[4:7], v[28:31]
    s_mov_b32 s58, 491520
    buffer_load_dwordx4 a[60:63], v58, s[20:23], s58 offen
    buffer_load_dwordx4 v[180:183], v5, s[8:11], s54 offen offset:1024 nt
    v_and_b32_dpp v18, v66, v14 row_newbcast:2 row_mask:0xf bank_mask:0xf
    v_and_b32_dpp v19, v66, v15 row_newbcast:2 row_mask:0xf bank_mask:0xf
    v_and_b32_dpp v20, v66, v16 row_newbcast:2 row_mask:0xf bank_mask:0xf
    v_and_b32_dpp v21, v66, v17 row_newbcast:2 row_mask:0xf bank_mask:0xf
    s_waitcnt vmcnt(26)
    s_nop 0
    v_mfma_f32_16x16x32_bf16 v[28:31], v[18:21], a[8:11], v[28:31]
    s_mov_b32 s58, 524288
    buffer_load_dwordx4 a[64:67], v58, s[20:23], s58 offen
    v_and_b32_dpp v22, v66, v14 row_newbcast:3 row_mask:0xf bank_mask:0xf
    v_and_b32_dpp v23, v66, v15 row_newbcast:3 row_mask:0xf bank_mask:0xf
    v_and_b32_dpp v24, v66, v16 row_newbcast:3 row_mask:0xf bank_mask:0xf
    v_and_b32_dpp v25, v66, v17 row_newbcast:3 row_mask:0xf bank_mask:0xf
    s_waitcnt vmcnt(26)
    s_nop 0
    v_mfma_f32_16x16x32_bf16 v[28:31], v[22:25], a[12:15], v[28:31]
    s_mov_b32 s58, 557056
    buffer_load_dwordx4 a[68:71], v58, s[20:23], s58 offen
    buffer_load_dwordx4 v[184:187], v5, s[8:11], s54 offen offset:2048 nt
    v_and_b32_dpp v18, v66, v14 row_newbcast:4 row_mask:0xf bank_mask:0xf
    v_and_b32_dpp v19, v66, v15 row_newbcast:4 row_mask:0xf bank_mask:0xf
    v_and_b32_dpp v20, v66, v16 row_newbcast:4 row_mask:0xf bank_mask:0xf
    v_and_b32_dpp v21, v66, v17 row_newbcast:4 row_mask:0xf bank_mask:0xf
    s_waitcnt vmcnt(26)
    s_nop 0
    v_mfma_f32_16x16x32_bf16 v[28:31], v[18:21], a[16:19], v[28:31]
    s_mov_b32 s58, 589824
    buffer_load_dwordx4 a[72:75], v58, s[20:23], s58 offen
    v_and_b32_dpp v22, v66, v14 row_newbcast:5 row_mask:0xf bank_mask:0xf
    v_and_b32_dpp v23, v66, v15 row_newbcast:5 row_mask:0xf bank_mask:0xf
    v_and_b32_dpp v24, v66, v16 row_newbcast:5 row_mask:0xf bank_mask:0xf
    v_and_b32_dpp v25, v66, v17 row_newbcast:5 row_mask:0xf bank_mask:0xf
    s_waitcnt vmcnt(26)
    s_nop 0
    v_mfma_f32_16x16x32_bf16 v[28:31], v[22:25], a[20:23], v[28:31]
    s_mov_b32 s58, 622592
    buffer_load_dwordx4 a[76:79], v58, s[20:23], s58 offen
    buffer_load_dwordx4 v[188:191], v5, s[8:11], s54 offen offset:3072 nt
    v_and_b32_dpp v18, v66, v14 row_newbcast:6 row_mask:0xf bank_mask:0xf
    v_and_b32_dpp v19, v66, v15 row_newbcast:6 row_mask:0xf bank_mask:0xf
    v_and_b32_dpp v20, v66, v16 row_newbcast:6 row_mask:0xf bank_mask:0xf
    v_and_b32_dpp v21, v66, v17 row_newbcast:6 row_mask:0xf bank_mask:0xf
    s_waitcnt vmcnt(26)
    s_nop 0
    v_mfma_f32_16x16x32_bf16 v[28:31], v[18:21], a[24:27], v[28:31]
    s_mov_b32 s58, 655360
    buffer_load_dwordx4 a[80:83], v58, s[20:23], s58 offen
    v_and_b32_dpp v22, v66, v14 row_newbcast:7 row_mask:0xf bank_mask:0xf
    v_and_b32_dpp v23, v66, v15 row_newbcast:7 row_mask:0xf bank_mask:0xf
    v_and_b32_dpp v24, v66, v16 row_newbcast:7 row_mask:0xf bank_mask:0xf
    v_and_b32_dpp v25, v66, v17 row_newbcast:7 row_mask:0xf bank_mask:0xf
    s_waitcnt vmcnt(26)
    s_nop 0
    v_mfma_f32_16x16x32_bf16 v[28:31], v[22:25], a[28:31], v[28:31]
    s_mov_b32 s58, 688128
    buffer_load_dwordx4 a[84:87], v58, s[20:23], s58 offen
    buffer_load_dwordx4 v[192:195], v6, s[8:11], s54 offen offset:0 nt
    v_and_b32_dpp v18, v66, v14 row_newbcast:8 row_mask:0xf bank_mask:0xf
    v_and_b32_dpp v19, v66, v15 row_newbcast:8 row_mask:0xf bank_mask:0xf
    v_and_b32_dpp v20, v66, v16 row_newbcast:8 row_mask:0xf bank_mask:0xf
    v_and_b32_dpp v21, v66, v17 row_newbcast:8 row_mask:0xf bank_mask:0xf
    s_waitcnt vmcnt(26)
    s_nop 0
    v_mfma_f32_16x16x32_bf16 v[28:31], v[18:21], a[32:35], v[28:31]
    s_mov_b32 s58, 720896
    buffer_load_dwordx4 a[88:91], v58, s[20:23], s58 offen
    v_and_b32_dpp v22, v66, v14 row_newbcast:9 row_mask:0xf bank_mask:0xf
    v_and_b32_dpp v23, v66, v15 row_newbcast:9 row_mask:0xf bank_mask:0xf
    v_and_b32_dpp v24, v66, v16 row_newbcast:9 row_mask:0xf bank_mask:0xf
    v_and_b32_dpp v25, v66, v17 row_newbcast:9 row_mask:0xf bank_mask:0xf
    s_waitcnt vmcnt(26)
    s_nop 0
    v_mfma_f32_16x16x32_bf16 v[28:31], v[22:25], a[36:39], v[28:31]
    s_mov_b32 s58, 753664
    buffer_load_dwordx4 a[92:95], v58, s[20:23], s58 offen
    buffer_load_dwordx4 v[196:199], v6, s[8:11], s54 offen offset:1024 nt
    v_and_b32_dpp v18, v66, v14 row_newbcast:10 row_mask:0xf bank_mask:0xf
    v_and_b32_dpp v19, v66, v15 row_newbcast:10 row_mask:0xf bank_mask:0xf
    v_and_b32_dpp v20, v66, v16 row_newbcast:10 row_mask:0xf bank_mask:0xf
    v_and_b32_dpp v21, v66, v17 row_newbcast:10 row_mask:0xf bank_mask:0xf
    s_waitcnt vmcnt(26)
    s_nop 0
    v_mfma_f32_16x16x32_bf16 v[28:31], v[18:21], a[40:43], v[28:31]
    s_mov_b32 s58, 786432
    buffer_load_dwordx4 a[96:99], v58, s[20:23], s58 offen
    v_and_b32_dpp v22, v66, v14 row_newbcast:11 row_mask:0xf bank_mask:0xf
    v_and_b32_dpp v23, v66, v15 row_newbcast:11 row_mask:0xf bank_mask:0xf
    v_and_b32_dpp v24, v66, v16 row_newbcast:11 row_mask:0xf bank_mask:0xf
    v_and_b32_dpp v25, v66, v17 row_newbcast:11 row_mask:0xf bank_mask:0xf
    s_waitcnt vmcnt(26)
    s_nop 0
    v_mfma_f32_16x16x32_bf16 v[28:31], v[22:25], a[44:47], v[28:31]
    s_mov_b32 s58, 819200
    buffer_load_dwordx4 a[100:103], v58, s[20:23], s58 offen
    buffer_load_dwordx4 v[200:203], v6, s[8:11], s54 offen offset:2048 nt
    v_and_b32_dpp v18, v66, v14 row_newbcast:12 row_mask:0xf bank_mask:0xf
    v_and_b32_dpp v19, v66, v15 row_newbcast:12 row_mask:0xf bank_mask:0xf
    v_and_b32_dpp v20, v66, v16 row_newbcast:12 row_mask:0xf bank_mask:0xf
    v_and_b32_dpp v21, v66, v17 row_newbcast:12 row_mask:0xf bank_mask:0xf
    s_waitcnt vmcnt(26)
    s_nop 0
    v_mfma_f32_16x16x32_bf16 v[28:31], v[18:21], a[48:51], v[28:31]
    s_mov_b32 s58, 851968
    buffer_load_dwordx4 a[104:107], v58, s[20:23], s58 offen
    v_and_b32_dpp v22, v66, v14 row_newbcast:13 row_mask:0xf bank_mask:0xf
    v_and_b32_dpp v23, v66, v15 row_newbcast:13 row_mask:0xf bank_mask:0xf
    v_and_b32_dpp v24, v66, v16 row_newbcast:13 row_mask:0xf bank_mask:0xf
    v_and_b32_dpp v25, v66, v17 row_newbcast:13 row_mask:0xf bank_mask:0xf
    s_waitcnt vmcnt(26)
    s_nop 0
    v_mfma_f32_16x16x32_bf16 v[28:31], v[22:25], a[52:55], v[28:31]
    s_mov_b32 s58, 884736
    buffer_load_dwordx4 a[108:111], v58, s[20:23], s58 offen
    buffer_load_dwordx4 v[204:207], v6, s[8:11], s54 offen offset:3072 nt
    v_and_b32_dpp v18, v66, v14 row_newbcast:14 row_mask:0xf bank_mask:0xf
    v_and_b32_dpp v19, v66, v15 row_newbcast:14 row_mask:0xf bank_mask:0xf
    v_and_b32_dpp v20, v66, v16 row_newbcast:14 row_mask:0xf bank_mask:0xf
    v_and_b32_dpp v21, v66, v17 row_newbcast:14 row_mask:0xf bank_mask:0xf
    s_waitcnt vmcnt(20)
    s_nop 0
    v_mfma_f32_16x16x32_bf16 v[28:31], v[18:21], a[56:59], v[28:31]
    s_mov_b32 s58, 917504
    buffer_load_dwordx4 a[112:115], v58, s[20:23], s58 offen
    v_and_b32_dpp v22, v66, v14 row_newbcast:15 row_mask:0xf bank_mask:0xf
    v_and_b32_dpp v23, v66, v15 row_newbcast:15 row_mask:0xf bank_mask:0xf
    v_and_b32_dpp v24, v66, v16 row_newbcast:15 row_mask:0xf bank_mask:0xf
    v_and_b32_dpp v25, v66, v17 row_newbcast:15 row_mask:0xf bank_mask:0xf
    s_waitcnt vmcnt(20)
    s_nop 0
    v_mfma_f32_16x16x32_bf16 v[28:31], v[22:25], a[60:63], v[28:31]
    s_mov_b32 s58, 950272
    buffer_load_dwordx4 a[116:119], v58, s[20:23], s58 offen
    buffer_load_dwordx4 v[208:211], v7, s[8:11], s54 offen offset:0 nt
    v_and_b32_dpp v18, v67, v14 row_newbcast:0 row_mask:0xf bank_mask:0xf
    v_and_b32_dpp v19, v67, v15 row_newbcast:0 row_mask:0xf bank_mask:0xf
    v_and_b32_dpp v20, v67, v16 row_newbcast:0 row_mask:0xf bank_mask:0xf
    v_and_b32_dpp v21, v67, v17 row_newbcast:0 row_mask:0xf bank_mask:0xf
    s_waitcnt vmcnt(20)
    s_nop 0
    v_mfma_f32_16x16x32_bf16 v[28:31], v[18:21], a[64:67], v[28:31]
    s_mov_b32 s58, 983040
    buffer_load_dwordx4 a[120:123], v58, s[20:23], s58 offen
    v_and_b32_dpp v22, v67, v14 row_newbcast:1 row_mask:0xf bank_mask:0xf
    v_and_b32_dpp v23, v67, v15 row_newbcast:1 row_mask:0xf bank_mask:0xf
    v_and_b32_dpp v24, v67, v16 row_newbcast:1 row_mask:0xf bank_mask:0xf
    v_and_b32_dpp v25, v67, v17 row_newbcast:1 row_mask:0xf bank_mask:0xf
    s_waitcnt vmcnt(20)
    s_nop 0
    v_mfma_f32_16x16x32_bf16 v[28:31], v[22:25], a[68:71], v[28:31]
    s_mov_b32 s58, 1015808
    buffer_load_dwordx4 a[124:127], v58, s[20:23], s58 offen
    buffer_load_dwordx4 v[212:215], v7, s[8:11], s54 offen offset:1024 nt
    v_and_b32_dpp v18, v67, v14 row_newbcast:2 row_mask:0xf bank_mask:0xf
    v_and_b32_dpp v19, v67, v15 row_newbcast:2 row_mask:0xf bank_mask:0xf
    v_and_b32_dpp v20, v67, v16 row_newbcast:2 row_mask:0xf bank_mask:0xf
    v_and_b32_dpp v21, v67, v17 row_newbcast:2 row_mask:0xf bank_mask:0xf
    s_waitcnt vmcnt(20)
    s_nop 0
    v_mfma_f32_16x16x32_bf16 v[28:31], v[18:21], a[72:75], v[28:31]
    v_and_b32_dpp v22, v67, v14 row_newbcast:3 row_mask:0xf bank_mask:0xf
    v_and_b32_dpp v23, v67, v15 row_newbcast:3 row_mask:0xf bank_mask:0xf
    v_and_b32_dpp v24, v67, v16 row_newbcast:3 row_mask:0xf bank_mask:0xf
    v_and_b32_dpp v25, v67, v17 row_newbcast:3 row_mask:0xf bank_mask:0xf
    s_waitcnt vmcnt(19)
    s_nop 0
    v_mfma_f32_16x16x32_bf16 v[28:31], v[22:25], a[76:79], v[28:31]
    buffer_load_dwordx4 v[216:219], v7, s[8:11], s54 offen offset:2048 nt
    v_and_b32_dpp v18, v67, v14 row_newbcast:4 row_mask:0xf bank_mask:0xf
    v_and_b32_dpp v19, v67, v15 row_newbcast:4 row_mask:0xf bank_mask:0xf
    v_and_b32_dpp v20, v67, v16 row_newbcast:4 row_mask:0xf bank_mask:0xf
    v_and_b32_dpp v21, v67, v17 row_newbcast:4 row_mask:0xf bank_mask:0xf
    s_waitcnt vmcnt(18)
    s_nop 0
    v_mfma_f32_16x16x32_bf16 v[28:31], v[18:21], a[80:83], v[28:31]
    v_and_b32_dpp v22, v67, v14 row_newbcast:5 row_mask:0xf bank_mask:0xf
    v_and_b32_dpp v23, v67, v15 row_newbcast:5 row_mask:0xf bank_mask:0xf
    v_and_b32_dpp v24, v67, v16 row_newbcast:5 row_mask:0xf bank_mask:0xf
    v_and_b32_dpp v25, v67, v17 row_newbcast:5 row_mask:0xf bank_mask:0xf
    s_waitcnt vmcnt(17)
    s_nop 0
    v_mfma_f32_16x16x32_bf16 v[28:31], v[22:25], a[84:87], v[28:31]
    buffer_load_dwordx4 v[220:223], v7, s[8:11], s54 offen offset:3072 nt
    v_and_b32_dpp v18, v67, v14 row_newbcast:6 row_mask:0xf bank_mask:0xf
    v_and_b32_dpp v19, v67, v15 row_newbcast:6 row_mask:0xf bank_mask:0xf
    v_and_b32_dpp v20, v67, v16 row_newbcast:6 row_mask:0xf bank_mask:0xf
    v_and_b32_dpp v21, v67, v17 row_newbcast:6 row_mask:0xf bank_mask:0xf
    s_waitcnt vmcnt(16)
    s_nop 0
    v_mfma_f32_16x16x32_bf16 v[28:31], v[18:21], a[88:91], v[28:31]
    v_and_b32_dpp v22, v67, v14 row_newbcast:7 row_mask:0xf bank_mask:0xf
    v_and_b32_dpp v23, v67, v15 row_newbcast:7 row_mask:0xf bank_mask:0xf
    v_and_b32_dpp v24, v67, v16 row_newbcast:7 row_mask:0xf bank_mask:0xf
    v_and_b32_dpp v25, v67, v17 row_newbcast:7 row_mask:0xf bank_mask:0xf
    s_waitcnt vmcnt(15)
    s_nop 0
    v_mfma_f32_16x16x32_bf16 v[28:31], v[22:25], a[92:95], v[28:31]
    buffer_load_dwordx4 v[224:227], v8, s[8:11], s54 offen offset:0 nt
    v_and_b32_dpp v18, v67, v14 row_newbcast:8 row_mask:0xf bank_mask:0xf
    v_and_b32_dpp v19, v67, v15 row_newbcast:8 row_mask:0xf bank_mask:0xf
    v_and_b32_dpp v20, v67, v16 row_newbcast:8 row_mask:0xf bank_mask:0xf
    v_and_b32_dpp v21, v67, v17 row_newbcast:8 row_mask:0xf bank_mask:0xf
    s_waitcnt vmcnt(14)
    s_nop 0
    v_mfma_f32_16x16x32_bf16 v[28:31], v[18:21], a[96:99], v[28:31]
    v_and_b32_dpp v22, v67, v14 row_newbcast:9 row_mask:0xf bank_mask:0xf
    v_and_b32_dpp v23, v67, v15 row_newbcast:9 row_mask:0xf bank_mask:0xf
    v_and_b32_dpp v24, v67, v16 row_newbcast:9 row_mask:0xf bank_mask:0xf
    v_and_b32_dpp v25, v67, v17 row_newbcast:9 row_mask:0xf bank_mask:0xf
    s_waitcnt vmcnt(13)
    s_nop 0
    v_mfma_f32_16x16x32_bf16 v[28:31], v[22:25], a[100:103], v[28:31]
    buffer_load_dwordx4 v[228:231], v8, s[8:11], s54 offen offset:1024 nt
    v_and_b32_dpp v18, v67, v14 row_newbcast:10 row_mask:0xf bank_mask:0xf
    v_and_b32_dpp v19, v67, v15 row_newbcast:10 row_mask:0xf bank_mask:0xf
    v_and_b32_dpp v20, v67, v16 row_newbcast:10 row_mask:0xf bank_mask:0xf
    v_and_b32_dpp v21, v67, v17 row_newbcast:10 row_mask:0xf bank_mask:0xf
    s_waitcnt vmcnt(12)
    s_nop 0
    v_mfma_f32_16x16x32_bf16 v[28:31], v[18:21], a[104:107], v[28:31]
    v_and_b32_dpp v22, v67, v14 row_newbcast:11 row_mask:0xf bank_mask:0xf
    v_and_b32_dpp v23, v67, v15 row_newbcast:11 row_mask:0xf bank_mask:0xf
    v_and_b32_dpp v24, v67, v16 row_newbcast:11 row_mask:0xf bank_mask:0xf
    v_and_b32_dpp v25, v67, v17 row_newbcast:11 row_mask:0xf bank_mask:0xf
    s_waitcnt vmcnt(11)
    s_nop 0
    v_mfma_f32_16x16x32_bf16 v[28:31], v[22:25], a[108:111], v[28:31]
    buffer_load_dwordx4 v[232:235], v8, s[8:11], s54 offen offset:2048 nt
    v_and_b32_dpp v18, v67, v14 row_newbcast:12 row_mask:0xf bank_mask:0xf
    v_and_b32_dpp v19, v67, v15 row_newbcast:12 row_mask:0xf bank_mask:0xf
    v_and_b32_dpp v20, v67, v16 row_newbcast:12 row_mask:0xf bank_mask:0xf
    v_and_b32_dpp v21, v67, v17 row_newbcast:12 row_mask:0xf bank_mask:0xf
    s_waitcnt vmcnt(10)
    s_nop 0
    v_mfma_f32_16x16x32_bf16 v[28:31], v[18:21], a[112:115], v[28:31]
    v_and_b32_dpp v22, v67, v14 row_newbcast:13 row_mask:0xf bank_mask:0xf
    v_and_b32_dpp v23, v67, v15 row_newbcast:13 row_mask:0xf bank_mask:0xf
    v_and_b32_dpp v24, v67, v16 row_newbcast:13 row_mask:0xf bank_mask:0xf
    v_and_b32_dpp v25, v67, v17 row_newbcast:13 row_mask:0xf bank_mask:0xf
    s_waitcnt vmcnt(9)
    s_nop 0
    v_mfma_f32_16x16x32_bf16 v[28:31], v[22:25], a[116:119], v[28:31]
    buffer_load_dwordx4 v[236:239], v8, s[8:11], s54 offen offset:3072 nt
    v_and_b32_dpp v18, v67, v14 row_newbcast:14 row_mask:0xf bank_mask:0xf
    v_and_b32_dpp v19, v67, v15 row_newbcast:14 row_mask:0xf bank_mask:0xf
    v_and_b32_dpp v20, v67, v16 row_newbcast:14 row_mask:0xf bank_mask:0xf
    v_and_b32_dpp v21, v67, v17 row_newbcast:14 row_mask:0xf bank_mask:0xf
    s_waitcnt vmcnt(8)
    s_nop 0
    v_mfma_f32_16x16x32_bf16 v[28:31], v[18:21], a[120:123], v[28:31]
    v_and_b32_dpp v22, v67, v14 row_newbcast:15 row_mask:0xf bank_mask:0xf
    v_and_b32_dpp v23, v67, v15 row_newbcast:15 row_mask:0xf bank_mask:0xf
    v_and_b32_dpp v24, v67, v16 row_newbcast:15 row_mask:0xf bank_mask:0xf
    v_and_b32_dpp v25, v67, v17 row_newbcast:15 row_mask:0xf bank_mask:0xf
    s_waitcnt vmcnt(7)
    s_nop 0
    v_mfma_f32_16x16x32_bf16 v[28:31], v[22:25], a[124:127], v[28:31]
    buffer_load_dwordx4 v[240:243], v9, s[8:11], s54 offen offset:0 nt
    buffer_load_dwordx4 v[244:247], v9, s[8:11], s54 offen offset:1024 nt
    buffer_load_dwordx4 v[248:251], v9, s[8:11], s54 offen offset:2048 nt
    v_lshlrev_b32 v27, 5, v75
    v_lshl_add_u32 v26, v74, 4, v27
    s_lshl_b32 s58, s3, 9
    v_add_u32 v26, s58, v26
    s_mov_b32 exec_hi, 0
    ds_write_b128 v26, v[28:31] offset:0
    s_mov_b64 exec, -1
    s_waitcnt lgkmcnt(0)
    s_barrier
    ds_read_b128 v[76:79], v27 offset:0
    ds_read_b128 v[80:83], v27 offset:16
    ds_read_b128 v[84:87], v27 offset:512
    ds_read_b128 v[88:91], v27 offset:528
    ds_read_b128 v[92:95], v27 offset:1024
    ds_read_b128 v[96:99], v27 offset:1040
    ds_read_b128 v[100:103], v27 offset:1536
    ds_read_b128 v[104:107], v27 offset:1552
    s_waitcnt lgkmcnt(0)
    v_add_f32 v76, v76, v84
    v_add_f32 v92, v92, v100
    v_add_f32 v77, v77, v85
    v_add_f32 v93, v93, v101
    v_add_f32 v78, v78, v86
    v_add_f32 v94, v94, v102
    v_add_f32 v79, v79, v87
    v_add_f32 v95, v95, v103
    v_add_f32 v80, v80, v88
    v_add_f32 v96, v96, v104
    v_add_f32 v81, v81, v89
    v_add_f32 v97, v97, v105
    v_add_f32 v82, v82, v90
    v_add_f32 v98, v98, v106
    v_add_f32 v83, v83, v91
    v_add_f32 v99, v99, v107
    v_add_f32 v76, v76, v92
    v_add_f32 v77, v77, v93
    v_add_f32 v78, v78, v94
    v_add_f32 v79, v79, v95
    v_add_f32 v80, v80, v96
    v_add_f32 v81, v81, v97
    v_add_f32 v82, v82, v98
    v_add_f32 v83, v83, v99
    v_cvt_pk_bf16_f32 v10, v76, v77
    v_cvt_pk_bf16_f32 v11, v78, v79
    v_cvt_pk_bf16_f32 v12, v80, v81
    v_cvt_pk_bf16_f32 v13, v82, v83
    v_lshlrev_b32 v27, 4, v75
    v_lshl_add_u32 v27, v74, 2, v27
    v_mov_b32 v64, 0xff800000
    v_mov_b32 v65, 0
    s_mov_b32 s55, 131072
    s_waitcnt vmcnt(63)
    v_dot2_f32_bf16 v48, v128, v10, 0
    v_dot2_f32_bf16 v48, v129, v11, v48
    v_dot2_f32_bf16 v48, v130, v12, v48
    v_dot2_f32_bf16 v48, v131, v13, v48
    s_waitcnt vmcnt(60)
    v_dot2_f32_bf16 v49, v132, v10, 0
    v_dot2_f32_bf16 v49, v133, v11, v49
    v_dot2_f32_bf16 v49, v134, v12, v49
    v_dot2_f32_bf16 v49, v135, v13, v49
    v_add_f32_dpp v50, v48, v48 row_ror:8 row_mask:0xf bank_mask:0x3
    s_nop 1
    v_add_f32_dpp v50, v49, v49 row_ror:8 row_mask:0xf bank_mask:0xc
    s_waitcnt vmcnt(57)
    buffer_load_dwordx4 v[252:255], v9, s[8:11], s54 offen offset:3072 nt
    v_dot2_f32_bf16 v48, v136, v10, 0
    v_dot2_f32_bf16 v48, v137, v11, v48
    v_dot2_f32_bf16 v48, v138, v12, v48
    v_dot2_f32_bf16 v48, v139, v13, v48
    s_waitcnt vmcnt(55)
    v_dot2_f32_bf16 v49, v140, v10, 0
    v_dot2_f32_bf16 v49, v141, v11, v49
    v_dot2_f32_bf16 v49, v142, v12, v49
    v_dot2_f32_bf16 v49, v143, v13, v49
    v_add_f32_dpp v51, v48, v48 row_ror:8 row_mask:0xf bank_mask:0x3
    s_nop 1
    v_add_f32_dpp v51, v49, v49 row_ror:8 row_mask:0xf bank_mask:0xc
    v_add_f32_dpp v52, v50, v50 row_half_mirror row_mask:0xf bank_mask:0x5
    s_nop 0
    v_add_f32_dpp v52, v51, v51 row_half_mirror row_mask:0xf bank_mask:0xa
    s_waitcnt vmcnt(52)
    v_dot2_f32_bf16 v48, v144, v10, 0
    v_dot2_f32_bf16 v48, v145, v11, v48
    v_dot2_f32_bf16 v48, v146, v12, v48
    v_dot2_f32_bf16 v48, v147, v13, v48
    s_waitcnt vmcnt(49)
    v_dot2_f32_bf16 v49, v148, v10, 0
    v_dot2_f32_bf16 v49, v149, v11, v49
    v_dot2_f32_bf16 v49, v150, v12, v49
    v_dot2_f32_bf16 v49, v151, v13, v49
    v_add_f32_dpp v50, v48, v48 row_ror:8 row_mask:0xf bank_mask:0x3
    s_nop 1
    v_add_f32_dpp v50, v49, v49 row_ror:8 row_mask:0xf bank_mask:0xc
    s_waitcnt vmcnt(46)
    v_dot2_f32_bf16 v48, v152, v10, 0
    v_dot2_f32_bf16 v48, v153, v11, v48
    v_dot2_f32_bf16 v48, v154, v12, v48
    v_dot2_f32_bf16 v48, v155, v13, v48
    s_waitcnt vmcnt(42)
    buffer_load_dwordx4 v[128:131], v2, s[12:15], s55 offen offset:0 nt
    v_dot2_f32_bf16 v49, v156, v10, 0
    v_dot2_f32_bf16 v49, v157, v11, v49
    v_dot2_f32_bf16 v49, v158, v12, v49
    v_dot2_f32_bf16 v49, v159, v13, v49
    v_add_f32_dpp v51, v48, v48 row_ror:8 row_mask:0xf bank_mask:0x3
    s_nop 1
    v_add_f32_dpp v51, v49, v49 row_ror:8 row_mask:0xf bank_mask:0xc
    v_add_f32_dpp v53, v50, v50 row_half_mirror row_mask:0xf bank_mask:0x5
    s_nop 0
    v_add_f32_dpp v53, v51, v51 row_half_mirror row_mask:0xf bank_mask:0xa
    v_add_f32_dpp v52, v52, v52 quad_perm:[2,3,0,1] row_mask:0xf bank_mask:0xf
    s_nop 0
    v_add_f32_dpp v53, v53, v53 quad_perm:[2,3,0,1] row_mask:0xf bank_mask:0xf
    v_cndmask_b32 v54, v52, v53, s[60:61]
    s_waitcnt vmcnt(42)
    v_dot2_f32_bf16 v48, v160, v10, 0
    v_dot2_f32_bf16 v48, v161, v11, v48
    v_dot2_f32_bf16 v48, v162, v12, v48
    v_dot2_f32_bf16 v48, v163, v13, v48
    s_waitcnt vmcnt(41)
    v_dot2_f32_bf16 v49, v164, v10, 0
    v_dot2_f32_bf16 v49, v165, v11, v49
    v_dot2_f32_bf16 v49, v166, v12, v49
    v_dot2_f32_bf16 v49, v167, v13, v49
    v_add_f32_dpp v50, v48, v48 row_ror:8 row_mask:0xf bank_mask:0x3
    s_nop 1
    v_add_f32_dpp v50, v49, v49 row_ror:8 row_mask:0xf bank_mask:0xc
    s_waitcnt vmcnt(40)
    v_dot2_f32_bf16 v48, v168, v10, 0
    v_dot2_f32_bf16 v48, v169, v11, v48
    v_dot2_f32_bf16 v48, v170, v12, v48
    v_dot2_f32_bf16 v48, v171, v13, v48
    s_waitcnt vmcnt(39)
    v_dot2_f32_bf16 v49, v172, v10, 0
    v_dot2_f32_bf16 v49, v173, v11, v49
    v_dot2_f32_bf16 v49, v174, v12, v49
    v_dot2_f32_bf16 v49, v175, v13, v49
    v_add_f32_dpp v51, v48, v48 row_ror:8 row_mask:0xf bank_mask:0x3
    s_nop 1
    v_add_f32_dpp v51, v49, v49 row_ror:8 row_mask:0xf bank_mask:0xc
    v_add_f32_dpp v52, v50, v50 row_half_mirror row_mask:0xf bank_mask:0x5
    s_nop 0
    v_add_f32_dpp v52, v51, v51 row_half_mirror row_mask:0xf bank_mask:0xa
    s_waitcnt vmcnt(38)
    buffer_load_dwordx4 v[132:135], v2, s[12:15], s55 offen offset:1024 nt
    v_dot2_f32_bf16 v48, v176, v10, 0
    v_dot2_f32_bf16 v48, v177, v11, v48
    v_dot2_f32_bf16 v48, v178, v12, v48
    v_dot2_f32_bf16 v48, v179, v13, v48
    s_waitcnt vmcnt(36)
    v_dot2_f32_bf16 v49, v180, v10, 0
    v_dot2_f32_bf16 v49, v181, v11, v49
    v_dot2_f32_bf16 v49, v182, v12, v49
    v_dot2_f32_bf16 v49, v183, v13, v49
    v_add_f32_dpp v50, v48, v48 row_ror:8 row_mask:0xf bank_mask:0x3
    s_nop 1
    v_add_f32_dpp v50, v49, v49 row_ror:8 row_mask:0xf bank_mask:0xc
    s_waitcnt vmcnt(33)
    v_dot2_f32_bf16 v48, v184, v10, 0
    v_dot2_f32_bf16 v48, v185, v11, v48
    v_dot2_f32_bf16 v48, v186, v12, v48
    v_dot2_f32_bf16 v48, v187, v13, v48
    s_waitcnt vmcnt(30)
    v_dot2_f32_bf16 v49, v188, v10, 0
    v_dot2_f32_bf16 v49, v189, v11, v49
    v_dot2_f32_bf16 v49, v190, v12, v49
    v_dot2_f32_bf16 v49, v191, v13, v49
    v_add_f32_dpp v51, v48, v48 row_ror:8 row_mask:0xf bank_mask:0x3
    s_nop 1
    v_add_f32_dpp v51, v49, v49 row_ror:8 row_mask:0xf bank_mask:0xc
    v_add_f32_dpp v53, v50, v50 row_half_mirror row_mask:0xf bank_mask:0x5
    s_nop 0
    v_add_f32_dpp v53, v51, v51 row_half_mirror row_mask:0xf bank_mask:0xa
    v_add_f32_dpp v52, v52, v52 quad_perm:[2,3,0,1] row_mask:0xf bank_mask:0xf
    s_nop 0
    v_add_f32_dpp v53, v53, v53 quad_perm:[2,3,0,1] row_mask:0xf bank_mask:0xf
    v_cndmask_b32 v55, v52, v53, s[60:61]
    v_add_f32_dpp v54, v54, v54 quad_perm:[1,0,3,2] row_mask:0xf bank_mask:0xf
    s_nop 0
    v_add_f32_dpp v55, v55, v55 quad_perm:[1,0,3,2] row_mask:0xf bank_mask:0xf
    v_cndmask_b32 v46, v54, v55, s[62:63]
    v_cvt_pk_bf16_f32 v46, v46, v46
    v_and_b32 v46, 0xffff0000, v46
    v_mul_f32 v46, s90, v46
    v_cvt_pk_bf16_f32 v46, v46, v46
    v_and_b32 v46, 0xffff0000, v46
    v_max_f32 v64, v64, v46
    s_waitcnt vmcnt(27)
    v_dot2_f32_bf16 v48, v192, v10, 0
    v_dot2_f32_bf16 v48, v193, v11, v48
    v_dot2_f32_bf16 v48, v194, v12, v48
    v_dot2_f32_bf16 v48, v195, v13, v48
    s_waitcnt vmcnt(24)
    buffer_load_dwordx4 v[136:139], v2, s[12:15], s55 offen offset:2048 nt
    v_dot2_f32_bf16 v49, v196, v10, 0
    v_dot2_f32_bf16 v49, v197, v11, v49
    v_dot2_f32_bf16 v49, v198, v12, v49
    v_dot2_f32_bf16 v49, v199, v13, v49
    v_add_f32_dpp v50, v48, v48 row_ror:8 row_mask:0xf bank_mask:0x3
    s_nop 1
    v_add_f32_dpp v50, v49, v49 row_ror:8 row_mask:0xf bank_mask:0xc
    s_waitcnt vmcnt(22)
    v_dot2_f32_bf16 v48, v200, v10, 0
    v_dot2_f32_bf16 v48, v201, v11, v48
    v_dot2_f32_bf16 v48, v202, v12, v48
    v_dot2_f32_bf16 v48, v203, v13, v48
    s_waitcnt vmcnt(19)
    v_dot2_f32_bf16 v49, v204, v10, 0
    v_dot2_f32_bf16 v49, v205, v11, v49
    v_dot2_f32_bf16 v49, v206, v12, v49
    v_dot2_f32_bf16 v49, v207, v13, v49
    v_add_f32_dpp v51, v48, v48 row_ror:8 row_mask:0xf bank_mask:0x3
    s_nop 1
    v_add_f32_dpp v51, v49, v49 row_ror:8 row_mask:0xf bank_mask:0xc
    v_add_f32_dpp v52, v50, v50 row_half_mirror row_mask:0xf bank_mask:0x5
    s_nop 0
    v_add_f32_dpp v52, v51, v51 row_half_mirror row_mask:0xf bank_mask:0xa
    s_waitcnt vmcnt(16)
    v_dot2_f32_bf16 v48, v208, v10, 0
    v_dot2_f32_bf16 v48, v209, v11, v48
    v_dot2_f32_bf16 v48, v210, v12, v48
    v_dot2_f32_bf16 v48, v211, v13, v48
    s_waitcnt vmcnt(13)
    v_dot2_f32_bf16 v49, v212, v10, 0
    v_dot2_f32_bf16 v49, v213, v11, v49
    v_dot2_f32_bf16 v49, v214, v12, v49
    v_dot2_f32_bf16 v49, v215, v13, v49
    v_add_f32_dpp v50, v48, v48 row_ror:8 row_mask:0xf bank_mask:0x3
    s_nop 1
    v_add_f32_dpp v50, v49, v49 row_ror:8 row_mask:0xf bank_mask:0xc
    s_waitcnt vmcnt(12)
    v_dot2_f32_bf16 v48, v216, v10, 0
    v_dot2_f32_bf16 v48, v217, v11, v48
    v_dot2_f32_bf16 v48, v218, v12, v48
    v_dot2_f32_bf16 v48, v219, v13, v48
    s_waitcnt vmcnt(11)
    v_dot2_f32_bf16 v49, v220, v10, 0
    v_dot2_f32_bf16 v49, v221, v11, v49
    v_dot2_f32_bf16 v49, v222, v12, v49
    v_dot2_f32_bf16 v49, v223, v13, v49
    v_add_f32_dpp v51, v48, v48 row_ror:8 row_mask:0xf bank_mask:0x3
    s_nop 1
    v_add_f32_dpp v51, v49, v49 row_ror:8 row_mask:0xf bank_mask:0xc
    v_add_f32_dpp v53, v50, v50 row_half_mirror row_mask:0xf bank_mask:0x5
    s_nop 0
    v_add_f32_dpp v53, v51, v51 row_half_mirror row_mask:0xf bank_mask:0xa
    v_add_f32_dpp v52, v52, v52 quad_perm:[2,3,0,1] row_mask:0xf bank_mask:0xf
    s_nop 0
    v_add_f32_dpp v53, v53, v53 quad_perm:[2,3,0,1] row_mask:0xf bank_mask:0xf
    v_cndmask_b32 v54, v52, v53, s[60:61]
    s_waitcnt vmcnt(10)
    v_dot2_f32_bf16 v48, v224, v10, 0
    v_dot2_f32_bf16 v48, v225, v11, v48
    v_dot2_f32_bf16 v48, v226, v12, v48
    v_dot2_f32_bf16 v48, v227, v13, v48
    s_waitcnt vmcnt(9)
    v_dot2_f32_bf16 v49, v228, v10, 0
    v_dot2_f32_bf16 v49, v229, v11, v49
    v_dot2_f32_bf16 v49, v230, v12, v49
    v_dot2_f32_bf16 v49, v231, v13, v49
    v_add_f32_dpp v50, v48, v48 row_ror:8 row_mask:0xf bank_mask:0x3
    s_nop 1
    v_add_f32_dpp v50, v49, v49 row_ror:8 row_mask:0xf bank_mask:0xc
    s_waitcnt vmcnt(8)
    v_dot2_f32_bf16 v48, v232, v10, 0
    v_dot2_f32_bf16 v48, v233, v11, v48
    v_dot2_f32_bf16 v48, v234, v12, v48
    v_dot2_f32_bf16 v48, v235, v13, v48
    s_waitcnt vmcnt(7)
    v_dot2_f32_bf16 v49, v236, v10, 0
    v_dot2_f32_bf16 v49, v237, v11, v49
    v_dot2_f32_bf16 v49, v238, v12, v49
    v_dot2_f32_bf16 v49, v239, v13, v49
    v_add_f32_dpp v51, v48, v48 row_ror:8 row_mask:0xf bank_mask:0x3
    s_nop 1
    v_add_f32_dpp v51, v49, v49 row_ror:8 row_mask:0xf bank_mask:0xc
    v_add_f32_dpp v52, v50, v50 row_half_mirror row_mask:0xf bank_mask:0x5
    s_nop 0
    v_add_f32_dpp v52, v51, v51 row_half_mirror row_mask:0xf bank_mask:0xa
    s_waitcnt vmcnt(6)
    v_dot2_f32_bf16 v48, v240, v10, 0
    v_dot2_f32_bf16 v48, v241, v11, v48
    v_dot2_f32_bf16 v48, v242, v12, v48
    v_dot2_f32_bf16 v48, v243, v13, v48
    s_waitcnt vmcnt(5)
    v_dot2_f32_bf16 v49, v244, v10, 0
    v_dot2_f32_bf16 v49, v245, v11, v49
    v_dot2_f32_bf16 v49, v246, v12, v49
    v_dot2_f32_bf16 v49, v247, v13, v49
    v_add_f32_dpp v50, v48, v48 row_ror:8 row_mask:0xf bank_mask:0x3
    s_nop 1
    v_add_f32_dpp v50, v49, v49 row_ror:8 row_mask:0xf bank_mask:0xc
    s_waitcnt vmcnt(4)
    buffer_load_dwordx4 v[140:143], v2, s[12:15], s55 offen offset:3072 nt
    v_dot2_f32_bf16 v48, v248, v10, 0
    v_dot2_f32_bf16 v48, v249, v11, v48
    v_dot2_f32_bf16 v48, v250, v12, v48
    v_dot2_f32_bf16 v48, v251, v13, v48
    s_waitcnt vmcnt(4)
    buffer_load_dwordx4 v[144:147], v3, s[12:15], s55 offen offset:0 nt
    v_dot2_f32_bf16 v49, v252, v10, 0
    v_dot2_f32_bf16 v49, v253, v11, v49
    v_dot2_f32_bf16 v49, v254, v12, v49
    v_dot2_f32_bf16 v49, v255, v13, v49
    v_add_f32_dpp v51, v48, v48 row_ror:8 row_mask:0xf bank_mask:0x3
    s_nop 1
    v_add_f32_dpp v51, v49, v49 row_ror:8 row_mask:0xf bank_mask:0xc
    v_add_f32_dpp v53, v50, v50 row_half_mirror row_mask:0xf bank_mask:0x5
    s_nop 0
    v_add_f32_dpp v53, v51, v51 row_half_mirror row_mask:0xf bank_mask:0xa
    v_add_f32_dpp v52, v52, v52 quad_perm:[2,3,0,1] row_mask:0xf bank_mask:0xf
    s_nop 0
    v_add_f32_dpp v53, v53, v53 quad_perm:[2,3,0,1] row_mask:0xf bank_mask:0xf
    v_cndmask_b32 v55, v52, v53, s[60:61]
    v_add_f32_dpp v54, v54, v54 quad_perm:[1,0,3,2] row_mask:0xf bank_mask:0xf
    s_nop 0
    v_add_f32_dpp v55, v55, v55 quad_perm:[1,0,3,2] row_mask:0xf bank_mask:0xf
    v_cndmask_b32 v47, v54, v55, s[62:63]
    v_cvt_pk_bf16_f32 v47, v47, v47
    v_and_b32 v47, 0xffff0000, v47
    v_mul_f32 v47, s90, v47
    v_cvt_pk_bf16_f32 v47, v47, v47
    v_and_b32 v47, 0xffff0000, v47
    v_max_f32 v64, v64, v47
    s_mov_b32 s54, s55
    s_add_u32 s55, s55, 131072
    v_mov_b32 v44, v46
    v_mov_b32 v45, v47
    s_waitcnt vmcnt(4)
    buffer_load_dwordx4 v[148:151], v3, s[8:11], s54 offen offset:1024 nt
    s_mov_b32 s58, 0
    buffer_load_dwordx4 a[0:3], v59, s[24:27], s58 offen
    v_dot2_f32_bf16 v48, v128, v10, 0
    v_dot2_f32_bf16 v48, v129, v11, v48
    v_dot2_f32_bf16 v48, v130, v12, v48
    v_dot2_f32_bf16 v48, v131, v13, v48
    s_waitcnt vmcnt(5)
    buffer_load_dwordx4 v[152:155], v3, s[8:11], s54 offen offset:2048 nt
    s_mov_b32 s58, 4096
    buffer_load_dwordx4 a[4:7], v59, s[24:27], s58 offen
    v_dot2_f32_bf16 v49, v132, v10, 0
    v_dot2_f32_bf16 v49, v133, v11, v49
    v_dot2_f32_bf16 v49, v134, v12, v49
    v_dot2_f32_bf16 v49, v135, v13, v49
    v_add_f32_dpp v50, v48, v48 row_ror:8 row_mask:0xf bank_mask:0x3
    s_nop 1
    v_add_f32_dpp v50, v49, v49 row_ror:8 row_mask:0xf bank_mask:0xc
    s_waitcnt vmcnt(6)
    buffer_load_dwordx4 v[156:159], v3, s[8:11], s54 offen offset:3072 nt
    s_mov_b32 s58, 8192
    buffer_load_dwordx4 a[8:11], v59, s[24:27], s58 offen
    v_dot2_f32_bf16 v48, v136, v10, 0
    v_dot2_f32_bf16 v48, v137, v11, v48
    v_dot2_f32_bf16 v48, v138, v12, v48
    v_dot2_f32_bf16 v48, v139, v13, v48
    s_waitcnt vmcnt(7)
    buffer_load_dwordx4 v[160:163], v4, s[8:11], s54 offen offset:0 nt
    s_mov_b32 s58, 12288
    buffer_load_dwordx4 a[12:15], v59, s[24:27], s58 offen
    v_dot2_f32_bf16 v49, v140, v10, 0
    v_dot2_f32_bf16 v49, v141, v11, v49
    v_dot2_f32_bf16 v49, v142, v12, v49
    v_dot2_f32_bf16 v49, v143, v13, v49
    v_add_f32_dpp v51, v48, v48 row_ror:8 row_mask:0xf bank_mask:0x3
    s_nop 1
    v_add_f32_dpp v51, v49, v49 row_ror:8 row_mask:0xf bank_mask:0xc
    v_add_f32_dpp v52, v50, v50 row_half_mirror row_mask:0xf bank_mask:0x5
    s_nop 0
    v_add_f32_dpp v52, v51, v51 row_half_mirror row_mask:0xf bank_mask:0xa
    s_waitcnt vmcnt(8)
    buffer_load_dwordx4 v[164:167], v4, s[8:11], s54 offen offset:1024 nt
    s_mov_b32 s58, 16384
    buffer_load_dwordx4 a[16:19], v59, s[24:27], s58 offen
    v_dot2_f32_bf16 v48, v144, v10, 0
    v_dot2_f32_bf16 v48, v145, v11, v48
    v_dot2_f32_bf16 v48, v146, v12, v48
    v_dot2_f32_bf16 v48, v147, v13, v48
    s_waitcnt vmcnt(9)
    buffer_load_dwordx4 v[168:171], v4, s[8:11], s54 offen offset:2048 nt
    s_mov_b32 s58, 20480
    buffer_load_dwordx4 a[20:23], v59, s[24:27], s58 offen
    v_dot2_f32_bf16 v49, v148, v10, 0
    v_dot2_f32_bf16 v49, v149, v11, v49
    v_dot2_f32_bf16 v49, v150, v12, v49
    v_dot2_f32_bf16 v49, v151, v13, v49
    v_add_f32_dpp v50, v48, v48 row_ror:8 row_mask:0xf bank_mask:0x3
    s_nop 1
    v_add_f32_dpp v50, v49, v49 row_ror:8 row_mask:0xf bank_mask:0xc
    s_waitcnt vmcnt(9)
    buffer_load_dwordx4 v[172:175], v4, s[8:11], s54 offen offset:3072 nt
    s_mov_b32 s58, 24576
    buffer_load_dwordx4 a[24:27], v59, s[24:27], s58 offen
    v_dot2_f32_bf16 v48, v152, v10, 0
    v_dot2_f32_bf16 v48, v153, v11, v48
    v_dot2_f32_bf16 v48, v154, v12, v48
    v_dot2_f32_bf16 v48, v155, v13, v48
    s_waitcnt vmcnt(9)
    buffer_load_dwordx4 v[176:179], v5, s[8:11], s54 offen offset:0 nt
    s_mov_b32 s58, 28672
    buffer_load_dwordx4 a[28:31], v59, s[24:27], s58 offen
    v_dot2_f32_bf16 v49, v156, v10, 0
    v_dot2_f32_bf16 v49, v157, v11, v49
    v_dot2_f32_bf16 v49, v158, v12, v49
    v_dot2_f32_bf16 v49, v159, v13, v49
    v_add_f32_dpp v51, v48, v48 row_ror:8 row_mask:0xf bank_mask:0x3
    s_nop 1
    v_add_f32_dpp v51, v49, v49 row_ror:8 row_mask:0xf bank_mask:0xc
    v_add_f32_dpp v53, v50, v50 row_half_mirror row_mask:0xf bank_mask:0x5
    s_nop 0
    v_add_f32_dpp v53, v51, v51 row_half_mirror row_mask:0xf bank_mask:0xa
    v_add_f32_dpp v52, v52, v52 quad_perm:[2,3,0,1] row_mask:0xf bank_mask:0xf
    s_nop 0
    v_add_f32_dpp v53, v53, v53 quad_perm:[2,3,0,1] row_mask:0xf bank_mask:0xf
    v_cndmask_b32 v54, v52, v53, s[60:61]
    s_waitcnt vmcnt(9)
    buffer_load_dwordx4 v[180:183], v5, s[8:11], s54 offen offset:1024 nt
    s_mov_b32 s58, 32768
    buffer_load_dwordx4 a[32:35], v59, s[24:27], s58 offen
    v_dot2_f32_bf16 v48, v160, v10, 0
    v_dot2_f32_bf16 v48, v161, v11, v48
    v_dot2_f32_bf16 v48, v162, v12, v48
    v_dot2_f32_bf16 v48, v163, v13, v48
    s_waitcnt vmcnt(9)
    buffer_load_dwordx4 v[184:187], v5, s[8:11], s54 offen offset:2048 nt
    s_mov_b32 s58, 36864
    buffer_load_dwordx4 a[36:39], v59, s[24:27], s58 offen
    v_dot2_f32_bf16 v49, v164, v10, 0
    v_dot2_f32_bf16 v49, v165, v11, v49
    v_dot2_f32_bf16 v49, v166, v12, v49
    v_dot2_f32_bf16 v49, v167, v13, v49
    v_add_f32_dpp v50, v48, v48 row_ror:8 row_mask:0xf bank_mask:0x3
    s_nop 1
    v_add_f32_dpp v50, v49, v49 row_ror:8 row_mask:0xf bank_mask:0xc
    s_waitcnt vmcnt(9)
    buffer_load_dwordx4 v[188:191], v5, s[8:11], s54 offen offset:3072 nt
    s_mov_b32 s58, 40960
    buffer_load_dwordx4 a[40:43], v59, s[24:27], s58 offen
    v_dot2_f32_bf16 v48, v168, v10, 0
    v_dot2_f32_bf16 v48, v169, v11, v48
    v_dot2_f32_bf16 v48, v170, v12, v48
    v_dot2_f32_bf16 v48, v171, v13, v48
    s_waitcnt vmcnt(9)
    buffer_load_dwordx4 v[192:195], v6, s[8:11], s54 offen offset:0 nt
    s_mov_b32 s58, 45056
    buffer_load_dwordx4 a[44:47], v59, s[24:27], s58 offen
    v_dot2_f32_bf16 v49, v172, v10, 0
    v_dot2_f32_bf16 v49, v173, v11, v49
    v_dot2_f32_bf16 v49, v174, v12, v49
    v_dot2_f32_bf16 v49, v175, v13, v49
    v_add_f32_dpp v51, v48, v48 row_ror:8 row_mask:0xf bank_mask:0x3
    s_nop 1
    v_add_f32_dpp v51, v49, v49 row_ror:8 row_mask:0xf bank_mask:0xc
    v_add_f32_dpp v52, v50, v50 row_half_mirror row_mask:0xf bank_mask:0x5
    s_nop 0
    v_add_f32_dpp v52, v51, v51 row_half_mirror row_mask:0xf bank_mask:0xa
    s_waitcnt vmcnt(9)
    buffer_load_dwordx4 v[196:199], v6, s[8:11], s54 offen offset:1024 nt
    s_mov_b32 s58, 49152
    buffer_load_dwordx4 a[48:51], v59, s[24:27], s58 offen
    v_dot2_f32_bf16 v48, v176, v10, 0
    v_dot2_f32_bf16 v48, v177, v11, v48
    v_dot2_f32_bf16 v48, v178, v12, v48
    v_dot2_f32_bf16 v48, v179, v13, v48
    s_waitcnt vmcnt(9)
    buffer_load_dwordx4 v[200:203], v6, s[8:11], s54 offen offset:2048 nt
    s_mov_b32 s58, 53248
    buffer_load_dwordx4 a[52:55], v59, s[24:27], s58 offen
    v_dot2_f32_bf16 v49, v180, v10, 0
    v_dot2_f32_bf16 v49, v181, v11, v49
    v_dot2_f32_bf16 v49, v182, v12, v49
    v_dot2_f32_bf16 v49, v183, v13, v49
    v_add_f32_dpp v50, v48, v48 row_ror:8 row_mask:0xf bank_mask:0x3
    s_nop 1
    v_add_f32_dpp v50, v49, v49 row_ror:8 row_mask:0xf bank_mask:0xc
    s_waitcnt vmcnt(9)
    buffer_load_dwordx4 v[204:207], v6, s[8:11], s54 offen offset:3072 nt
    s_mov_b32 s58, 57344
    buffer_load_dwordx4 a[56:59], v59, s[24:27], s58 offen
    v_dot2_f32_bf16 v48, v184, v10, 0
    v_dot2_f32_bf16 v48, v185, v11, v48
    v_dot2_f32_bf16 v48, v186, v12, v48
    v_dot2_f32_bf16 v48, v187, v13, v48
    s_waitcnt vmcnt(9)
    buffer_load_dwordx4 v[208:211], v7, s[8:11], s54 offen offset:0 nt
    s_mov_b32 s58, 61440
    buffer_load_dwordx4 a[60:63], v59, s[24:27], s58 offen
    v_dot2_f32_bf16 v49, v188, v10, 0
    v_dot2_f32_bf16 v49, v189, v11, v49
    v_dot2_f32_bf16 v49, v190, v12, v49
    v_dot2_f32_bf16 v49, v191, v13, v49
    v_add_f32_dpp v51, v48, v48 row_ror:8 row_mask:0xf bank_mask:0x3
    s_nop 1
    v_add_f32_dpp v51, v49, v49 row_ror:8 row_mask:0xf bank_mask:0xc
    v_add_f32_dpp v53, v50, v50 row_half_mirror row_mask:0xf bank_mask:0x5
    s_nop 0
    v_add_f32_dpp v53, v51, v51 row_half_mirror row_mask:0xf bank_mask:0xa
    v_add_f32_dpp v52, v52, v52 quad_perm:[2,3,0,1] row_mask:0xf bank_mask:0xf
    s_nop 0
    v_add_f32_dpp v53, v53, v53 quad_perm:[2,3,0,1] row_mask:0xf bank_mask:0xf
    v_cndmask_b32 v55, v52, v53, s[60:61]
    v_add_f32_dpp v54, v54, v54 quad_perm:[1,0,3,2] row_mask:0xf bank_mask:0xf
    s_nop 0
    v_add_f32_dpp v55, v55, v55 quad_perm:[1,0,3,2] row_mask:0xf bank_mask:0xf
    v_cndmask_b32 v46, v54, v55, s[62:63]
    v_cvt_pk_bf16_f32 v46, v46, v46
    v_and_b32 v46, 0xffff0000, v46
    v_mul_f32 v46, s90, v46
    v_cvt_pk_bf16_f32 v46, v46, v46
    v_and_b32 v46, 0xffff0000, v46
    v_max_f32 v64, v64, v46
    s_waitcnt vmcnt(9)
    buffer_load_dwordx4 v[212:215], v7, s[8:11], s54 offen offset:1024 nt
    s_mov_b32 s58, 65536
    buffer_load_dwordx4 a[64:67], v59, s[24:27], s58 offen
    v_dot2_f32_bf16 v48, v192, v10, 0
    v_dot2_f32_bf16 v48, v193, v11, v48
    v_dot2_f32_bf16 v48, v194, v12, v48
    v_dot2_f32_bf16 v48, v195, v13, v48
    s_waitcnt vmcnt(9)
    buffer_load_dwordx4 v[216:219], v7, s[8:11], s54 offen offset:2048 nt
    s_mov_b32 s58, 69632
    buffer_load_dwordx4 a[68:71], v59, s[24:27], s58 offen
    v_dot2_f32_bf16 v49, v196, v10, 0
    v_dot2_f32_bf16 v49, v197, v11, v49
    v_dot2_f32_bf16 v49, v198, v12, v49
    v_dot2_f32_bf16 v49, v199, v13, v49
    v_add_f32_dpp v50, v48, v48 row_ror:8 row_mask:0xf bank_mask:0x3
    s_nop 1
    v_add_f32_dpp v50, v49, v49 row_ror:8 row_mask:0xf bank_mask:0xc
    s_waitcnt vmcnt(9)
    buffer_load_dwordx4 v[220:223], v7, s[8:11], s54 offen offset:3072 nt
    s_mov_b32 s58, 73728
    buffer_load_dwordx4 a[72:75], v59, s[24:27], s58 offen
    v_dot2_f32_bf16 v48, v200, v10, 0
    v_dot2_f32_bf16 v48, v201, v11, v48
    v_dot2_f32_bf16 v48, v202, v12, v48
    v_dot2_f32_bf16 v48, v203, v13, v48
    s_waitcnt vmcnt(9)
    buffer_load_dwordx4 v[224:227], v8, s[8:11], s54 offen offset:0 nt
    s_mov_b32 s58, 77824
    buffer_load_dwordx4 a[76:79], v59, s[24:27], s58 offen
    v_dot2_f32_bf16 v49, v204, v10, 0
    v_dot2_f32_bf16 v49, v205, v11, v49
    v_dot2_f32_bf16 v49, v206, v12, v49
    v_dot2_f32_bf16 v49, v207, v13, v49
    v_add_f32_dpp v51, v48, v48 row_ror:8 row_mask:0xf bank_mask:0x3
    s_nop 1
    v_add_f32_dpp v51, v49, v49 row_ror:8 row_mask:0xf bank_mask:0xc
    v_add_f32_dpp v52, v50, v50 row_half_mirror row_mask:0xf bank_mask:0x5
    s_nop 0
    v_add_f32_dpp v52, v51, v51 row_half_mirror row_mask:0xf bank_mask:0xa
    s_waitcnt vmcnt(9)
    buffer_load_dwordx4 v[228:231], v8, s[8:11], s54 offen offset:1024 nt
    s_mov_b32 s58, 81920
    buffer_load_dwordx4 a[80:83], v59, s[24:27], s58 offen
    v_dot2_f32_bf16 v48, v208, v10, 0
    v_dot2_f32_bf16 v48, v209, v11, v48
    v_dot2_f32_bf16 v48, v210, v12, v48
    v_dot2_f32_bf16 v48, v211, v13, v48
    s_waitcnt vmcnt(9)
    buffer_load_dwordx4 v[232:235], v8, s[8:11], s54 offen offset:2048 nt
    s_mov_b32 s58, 86016
    buffer_load_dwordx4 a[84:87], v59, s[24:27], s58 offen
    v_dot2_f32_bf16 v49, v212, v10, 0
    v_dot2_f32_bf16 v49, v213, v11, v49
    v_dot2_f32_bf16 v49, v214, v12, v49
    v_dot2_f32_bf16 v49, v215, v13, v49
    v_add_f32_dpp v50, v48, v48 row_ror:8 row_mask:0xf bank_mask:0x3
    s_nop 1
    v_add_f32_dpp v50, v49, v49 row_ror:8 row_mask:0xf bank_mask:0xc
    s_waitcnt vmcnt(9)
    buffer_load_dwordx4 v[236:239], v8, s[8:11], s54 offen offset:3072 nt
    s_mov_b32 s58, 90112
    buffer_load_dwordx4 a[88:91], v59, s[24:27], s58 offen
    v_dot2_f32_bf16 v48, v216, v10, 0
    v_dot2_f32_bf16 v48, v217, v11, v48
    v_dot2_f32_bf16 v48, v218, v12, v48
    v_dot2_f32_bf16 v48, v219, v13, v48
    s_waitcnt vmcnt(9)
    buffer_load_dwordx4 v[240:243], v9, s[8:11], s54 offen offset:0 nt
    s_mov_b32 s58, 94208
    buffer_load_dwordx4 a[92:95], v59, s[24:27], s58 offen
    v_dot2_f32_bf16 v49, v220, v10, 0
    v_dot2_f32_bf16 v49, v221, v11, v49
    v_dot2_f32_bf16 v49, v222, v12, v49
    v_dot2_f32_bf16 v49, v223, v13, v49
    v_add_f32_dpp v51, v48, v48 row_ror:8 row_mask:0xf bank_mask:0x3
    s_nop 1
    v_add_f32_dpp v51, v49, v49 row_ror:8 row_mask:0xf bank_mask:0xc
    v_add_f32_dpp v53, v50, v50 row_half_mirror row_mask:0xf bank_mask:0x5
    s_nop 0
    v_add_f32_dpp v53, v51, v51 row_half_mirror row_mask:0xf bank_mask:0xa
    v_add_f32_dpp v52, v52, v52 quad_perm:[2,3,0,1] row_mask:0xf bank_mask:0xf
    s_nop 0
    v_add_f32_dpp v53, v53, v53 quad_perm:[2,3,0,1] row_mask:0xf bank_mask:0xf
    v_cndmask_b32 v54, v52, v53, s[60:61]
    s_waitcnt vmcnt(9)
    buffer_load_dwordx4 v[244:247], v9, s[8:11], s54 offen offset:1024 nt
    s_mov_b32 s58, 98304
    buffer_load_dwordx4 a[96:99], v59, s[24:27], s58 offen
    v_dot2_f32_bf16 v48, v224, v10, 0
    v_dot2_f32_bf16 v48, v225, v11, v48
    v_dot2_f32_bf16 v48, v226, v12, v48
    v_dot2_f32_bf16 v48, v227, v13, v48
    s_waitcnt vmcnt(9)
    buffer_load_dwordx4 v[248:251], v9, s[8:11], s54 offen offset:2048 nt
    s_mov_b32 s58, 102400
    buffer_load_dwordx4 a[100:103], v59, s[24:27], s58 offen
    v_dot2_f32_bf16 v49, v228, v10, 0
    v_dot2_f32_bf16 v49, v229, v11, v49
    v_dot2_f32_bf16 v49, v230, v12, v49
    v_dot2_f32_bf16 v49, v231, v13, v49
    v_add_f32_dpp v50, v48, v48 row_ror:8 row_mask:0xf bank_mask:0x3
    s_nop 1
    v_add_f32_dpp v50, v49, v49 row_ror:8 row_mask:0xf bank_mask:0xc
    s_waitcnt vmcnt(9)
    buffer_load_dwordx4 v[252:255], v9, s[8:11], s54 offen offset:3072 nt
    s_mov_b32 s58, 106496
    buffer_load_dwordx4 a[104:107], v59, s[24:27], s58 offen
    v_dot2_f32_bf16 v48, v232, v10, 0
    v_dot2_f32_bf16 v48, v233, v11, v48
    v_dot2_f32_bf16 v48, v234, v12, v48
    v_dot2_f32_bf16 v48, v235, v13, v48
    s_waitcnt vmcnt(9)
    buffer_load_dwordx4 v[128:131], v2, s[12:15], s55 offen offset:0 nt
    s_mov_b32 s58, 110592
    buffer_load_dwordx4 a[108:111], v59, s[24:27], s58 offen
    v_dot2_f32_bf16 v49, v236, v10, 0
    v_dot2_f32_bf16 v49, v237, v11, v49
    v_dot2_f32_bf16 v49, v238, v12, v49
    v_dot2_f32_bf16 v49, v239, v13, v49
    v_add_f32_dpp v51, v48, v48 row_ror:8 row_mask:0xf bank_mask:0x3
    s_nop 1
    v_add_f32_dpp v51, v49, v49 row_ror:8 row_mask:0xf bank_mask:0xc
    v_add_f32_dpp v52, v50, v50 row_half_mirror row_mask:0xf bank_mask:0x5
    s_nop 0
    v_add_f32_dpp v52, v51, v51 row_half_mirror row_mask:0xf bank_mask:0xa
    s_waitcnt vmcnt(9)
    buffer_load_dwordx4 v[132:135], v2, s[12:15], s55 offen offset:1024 nt
    s_mov_b32 s58, 114688
    buffer_load_dwordx4 a[112:115], v59, s[24:27], s58 offen
    v_dot2_f32_bf16 v48, v240, v10, 0
    v_dot2_f32_bf16 v48, v241, v11, v48
    v_dot2_f32_bf16 v48, v242, v12, v48
    v_dot2_f32_bf16 v48, v243, v13, v48
    s_waitcnt vmcnt(9)
    buffer_load_dwordx4 v[136:139], v2, s[12:15], s55 offen offset:2048 nt
    s_mov_b32 s58, 118784
    buffer_load_dwordx4 a[116:119], v59, s[24:27], s58 offen
    v_dot2_f32_bf16 v49, v244, v10, 0
    v_dot2_f32_bf16 v49, v245, v11, v49
    v_dot2_f32_bf16 v49, v246, v12, v49
    v_dot2_f32_bf16 v49, v247, v13, v49
    v_add_f32_dpp v50, v48, v48 row_ror:8 row_mask:0xf bank_mask:0x3
    s_nop 1
    v_add_f32_dpp v50, v49, v49 row_ror:8 row_mask:0xf bank_mask:0xc
    s_waitcnt vmcnt(9)
    buffer_load_dwordx4 v[140:143], v2, s[12:15], s55 offen offset:3072 nt
    s_mov_b32 s58, 122880
    buffer_load_dwordx4 a[120:123], v59, s[24:27], s58 offen
    v_dot2_f32_bf16 v48, v248, v10, 0
    v_dot2_f32_bf16 v48, v249, v11, v48
    v_dot2_f32_bf16 v48, v250, v12, v48
    v_dot2_f32_bf16 v48, v251, v13, v48
    s_waitcnt vmcnt(9)
    buffer_load_dwordx4 v[144:147], v3, s[12:15], s55 offen offset:0 nt
    s_mov_b32 s58, 126976
    buffer_load_dwordx4 a[124:127], v59, s[24:27], s58 offen
    v_dot2_f32_bf16 v49, v252, v10, 0
    v_dot2_f32_bf16 v49, v253, v11, v49
    v_dot2_f32_bf16 v49, v254, v12, v49
    v_dot2_f32_bf16 v49, v255, v13, v49
    v_add_f32_dpp v51, v48, v48 row_ror:8 row_mask:0xf bank_mask:0x3
    s_nop 1
    v_add_f32_dpp v51, v49, v49 row_ror:8 row_mask:0xf bank_mask:0xc
    v_add_f32_dpp v53, v50, v50 row_half_mirror row_mask:0xf bank_mask:0x5
    s_nop 0
    v_add_f32_dpp v53, v51, v51 row_half_mirror row_mask:0xf bank_mask:0xa
    v_add_f32_dpp v52, v52, v52 quad_perm:[2,3,0,1] row_mask:0xf bank_mask:0xf
    s_nop 0
    v_add_f32_dpp v53, v53, v53 quad_perm:[2,3,0,1] row_mask:0xf bank_mask:0xf
    v_cndmask_b32 v55, v52, v53, s[60:61]
    v_add_f32_dpp v54, v54, v54 quad_perm:[1,0,3,2] row_mask:0xf bank_mask:0xf
    s_nop 0
    v_add_f32_dpp v55, v55, v55 quad_perm:[1,0,3,2] row_mask:0xf bank_mask:0xf
    v_cndmask_b32 v47, v54, v55, s[62:63]
    v_cvt_pk_bf16_f32 v47, v47, v47
    v_and_b32 v47, 0xffff0000, v47
    v_mul_f32 v47, s90, v47
    v_cvt_pk_bf16_f32 v47, v47, v47
    v_and_b32 v47, 0xffff0000, v47
    v_max_f32 v64, v64, v47
    s_mov_b32 s56, 2
    s_memrealtime s[52:53]
    s_mov_b32 s51, 5
    s_mov_b32 s50, 99
    s_mov_b32 s57, 0
    s_mov_b32 s48, s18
    s_mov_b32 s49, 0x40000000
    s_mov_b32 s100, 0x20000000
    s_mov_b32 s92, 0
    s_mov_b32 s24, 0x20000000
    s_mov_b32 s25, 0
    s_mov_b32 s88, 0
    s_mov_b32 s93, 2147483648
    v_mov_b32 v72, 0
    s_cmp_eq_u32 s7, 1
    s_cselect_b32 s19, 0, 0
    s_cmp_eq_u32 s7, 3
    s_cselect_b32 s19, 0, s19
.p2align 3
L_k:
    s_mov_b32 s54, s55
    s_add_u32 s55, s55, 131072
    s_cmp_eq_u32 s56, 7
    s_cselect_b32 s12, s16, s12
    s_cselect_b32 s13, s17, s13
    s_cselect_b32 s55, 0, s55
    v_mov_b32 v32, v34
    v_mov_b32 v33, v35
    v_mov_b32 v34, v36
    v_mov_b32 v35, v37
    v_mov_b32 v36, v38
    v_mov_b32 v37, v39
    v_mov_b32 v38, v40
    v_mov_b32 v39, v41
    v_mov_b32 v40, v42
    v_mov_b32 v41, v43
    v_mov_b32 v42, v44
    v_mov_b32 v43, v45
    v_mov_b32 v44, v46
    v_mov_b32 v45, v47
    s_waitcnt lgkmcnt(0)
    s_cmp_eq_u32 s56, 3
    s_cselect_b32 s88, s52, s88
    s_cmp_eq_u32 s56, 4
    s_cselect_b32 s92, s52, s92
    s_lshl_b32 s58, s6, 4
    s_add_u32 s58, s58, s56
    s_cmp_eq_u32 s58, 37
    s_cbranch_scc0 L_norep
    s_waitcnt lgkmcnt(0)
    s_sub_u32 s58, s52, s88
    s_sub_u32 s88, s92, s88
    s_sub_u32 s92, s52, s92
    s_min_u32 s88, s88, s92
    s_lshl_b32 s88, s88, 1
    s_add_u32 s92, s88, 50
    s_cmp_gt_u32 s58, s92
    s_cselect_b32 s58, s88, s58
    s_min_u32 s58, s58, 0x7fff
    s_max_u32 s58, s58, 1
    s_pack_ll_b32_b16 s58, s52, s58
    v_mov_b32 v61, s58
    s_lshl_b32 s58, s89, 2
    v_mov_b32 v60, s58
    s_mov_b64 exec, 1
    global_store_dword v60, v61, s[84:85] sc1
    s_mov_b64 exec, -1
L_norep:
    s_cmp_lg_u32 s50, 0
    s_cbranch_scc0 L_nocalK
    s_cmp_ge_u32 s56, 6
    s_cbranch_scc0 L_nocalK
    v_cmp_eq_u32 vcc, 0, v72
    s_cbranch_vccz L_calK
    v_lshlrev_b32 v60, 2, v1
    global_load_dword v72, v60, s[84:85] sc1
    s_branch L_nocalK
L_calK:
    s_mov_b32 s50, 0
    s_waitcnt lgkmcnt(0)
    s_mov_b32 s100, 0x20000000
    s_mov_b32 s48, s52
    v_bfe_u32 v60, v72, 16, 15
    v_subrev_u32 v61, s52, v72
    v_bfe_i32 v61, v61, 0, 16
    v_add_u32_dpp v60, v60, v60 row_ror:8 row_mask:0xf bank_mask:0xf
    s_nop 1
    v_add_u32_dpp v60, v60, v60 row_ror:4 row_mask:0xf bank_mask:0xf
    s_nop 1
    v_add_u32_dpp v60, v60, v60 row_ror:2 row_mask:0xf bank_mask:0xf
    s_nop 1
    v_add_u32_dpp v60, v60, v60 row_ror:1 row_mask:0xf bank_mask:0xf
    v_mov_b32 v62, v60
    s_nop 1
    v_permlane16_swap_b32 v60, v62
    v_add_u32 v60, v60, v62
    v_mov_b32 v62, v60
    s_nop 1
    v_permlane32_swap_b32 v60, v62
    v_add_u32 v60, v60, v62
    v_add_u32_dpp v61, v61, v61 row_ror:8 row_mask:0xf bank_mask:0xf
    s_nop 1
    v_add_u32_dpp v61, v61, v61 row_ror:4 row_mask:0xf bank_mask:0xf
    s_nop 1
    v_add_u32_dpp v61, v61, v61 row_ror:2 row_mask:0xf bank_mask:0xf
    s_nop 1
    v_add_u32_dpp v61, v61, v61 row_ror:1 row_mask:0xf bank_mask:0xf
    v_mov_b32 v62, v61
    s_nop 1
    v_permlane16_swap_b32 v61, v62
    v_add_u32 v61, v61, v62
    v_mov_b32 v62, v61
    s_nop 1
    v_permlane32_swap_b32 v61, v62
    v_add_u32 v61, v61, v62
    v_readfirstlane_b32 s57, v60
    v_readfirstlane_b32 s49, v61
    s_add_u32 s58, s56, -5
    s_lshl_b32 s58, s58, 1
    s_mul_i32 s58, s58, s57
    s_lshl_b32 s49, s49, 2
    s_add_u32 s49, s49, s58
    s_mov_b32 s58, 20480
    s_cmp_eq_u32 s7, 1
    s_cselect_b32 s58, 5120, s58
    s_cmp_eq_u32 s7, 3
    s_cselect_b32 s58, 0, s58
    s_add_u32 s49, s49, s58
L_nocalK:
    s_waitcnt lgkmcnt(0)
    s_sub_u32 s58, s52, s48
    s_lshl_b32 s58, s58, 8
    s_sub_u32 s58, s58, s49
    s_add_u32 s49, s49, s57
    s_sub_u32 s101, s58, s100
    s_cmp_gt_i32 s101, 30720
    s_cselect_b32 s101, 56320, 0
    s_add_u32 s49, s49, s101
    s_sub_u32 s58, s58, s101
    s_mov_b32 s100, s58
    s_sub_u32 s19, s19, 1
    s_cmp_ge_i32 s19, 0
    s_cselect_b32 s58, 1, s58
    s_cmp_gt_i32 s58, 0
    s_cbranch_scc1 L_k_0_6
L_k_0_5:
    s_waitcnt vmcnt(4)
    s_cmp_gt_u32 s51, 5
    s_cbranch_scc1 L_k_0_5_s0
    buffer_load_dwordx4 v[148:151], v3, s[8:11], s54 offen offset:1024 nt
L_k_0_5_s0:
    v_dot2_f32_bf16 v48, v128, v10, 0
    v_dot2_f32_bf16 v48, v129, v11, v48
    v_dot2_f32_bf16 v48, v130, v12, v48
    v_dot2_f32_bf16 v48, v131, v13, v48
    s_waitcnt vmcnt(4)
    buffer_load_dwordx4 v[152:155], v3, s[8:11], s54 offen offset:2048 nt
    s_mov_b32 s51, 5
    v_dot2_f32_bf16 v49, v132, v10, 0
    v_dot2_f32_bf16 v49, v133, v11, v49
    v_dot2_f32_bf16 v49, v134, v12, v49
    v_dot2_f32_bf16 v49, v135, v13, v49
    v_add_f32_dpp v50, v48, v48 row_ror:8 row_mask:0xf bank_mask:0x3
    s_nop 1
    v_add_f32_dpp v50, v49, v49 row_ror:8 row_mask:0xf bank_mask:0xc
    s_waitcnt vmcnt(4)
    buffer_load_dwordx4 v[156:159], v3, s[8:11], s54 offen offset:3072 nt
    v_dot2_f32_bf16 v48, v136, v10, 0
    v_dot2_f32_bf16 v48, v137, v11, v48
    v_dot2_f32_bf16 v48, v138, v12, v48
    v_dot2_f32_bf16 v48, v139, v13, v48
    s_waitcnt vmcnt(4)
    buffer_load_dwordx4 v[160:163], v4, s[8:11], s54 offen offset:0 nt
    v_dot2_f32_bf16 v49, v140, v10, 0
    v_dot2_f32_bf16 v49, v141, v11, v49
    v_dot2_f32_bf16 v49, v142, v12, v49
    v_dot2_f32_bf16 v49, v143, v13, v49
    v_add_f32_dpp v51, v48, v48 row_ror:8 row_mask:0xf bank_mask:0x3
    s_nop 1
    v_add_f32_dpp v51, v49, v49 row_ror:8 row_mask:0xf bank_mask:0xc
    v_add_f32_dpp v52, v50, v50 row_half_mirror row_mask:0xf bank_mask:0x5
    s_nop 0
    v_add_f32_dpp v52, v51, v51 row_half_mirror row_mask:0xf bank_mask:0xa
    s_waitcnt vmcnt(4)
    buffer_load_dwordx4 v[164:167], v4, s[8:11], s54 offen offset:1024 nt
    v_dot2_f32_bf16 v48, v144, v10, 0
    v_dot2_f32_bf16 v48, v145, v11, v48
    v_dot2_f32_bf16 v48, v146, v12, v48
    v_dot2_f32_bf16 v48, v147, v13, v48
    s_waitcnt vmcnt(4)
    buffer_load_dwordx4 v[168:171], v4, s[8:11], s54 offen offset:2048 nt
    v_dot2_f32_bf16 v49, v148, v10, 0
    v_dot2_f32_bf16 v49, v149, v11, v49
    v_dot2_f32_bf16 v49, v150, v12, v49
    v_dot2_f32_bf16 v49, v151, v13, v49
    v_add_f32_dpp v50, v48, v48 row_ror:8 row_mask:0xf bank_mask:0x3
    s_nop 1
    v_add_f32_dpp v50, v49, v49 row_ror:8 row_mask:0xf bank_mask:0xc
    s_waitcnt vmcnt(4)
    buffer_load_dwordx4 v[172:175], v4, s[8:11], s54 offen offset:3072 nt
    v_dot2_f32_bf16 v48, v152, v10, 0
    v_dot2_f32_bf16 v48, v153, v11, v48
    v_dot2_f32_bf16 v48, v154, v12, v48
    v_dot2_f32_bf16 v48, v155, v13, v48
    s_waitcnt vmcnt(4)
    buffer_load_dwordx4 v[176:179], v5, s[8:11], s54 offen offset:0 nt
    v_dot2_f32_bf16 v49, v156, v10, 0
    v_dot2_f32_bf16 v49, v157, v11, v49
    v_dot2_f32_bf16 v49, v158, v12, v49
    v_dot2_f32_bf16 v49, v159, v13, v49
    v_add_f32_dpp v51, v48, v48 row_ror:8 row_mask:0xf bank_mask:0x3
    s_nop 1
    v_add_f32_dpp v51, v49, v49 row_ror:8 row_mask:0xf bank_mask:0xc
    v_add_f32_dpp v53, v50, v50 row_half_mirror row_mask:0xf bank_mask:0x5
    s_nop 0
    v_add_f32_dpp v53, v51, v51 row_half_mirror row_mask:0xf bank_mask:0xa
    v_add_f32_dpp v52, v52, v52 quad_perm:[2,3,0,1] row_mask:0xf bank_mask:0xf
    s_nop 0
    v_add_f32_dpp v53, v53, v53 quad_perm:[2,3,0,1] row_mask:0xf bank_mask:0xf
    v_cndmask_b32 v54, v52, v53, s[60:61]
    s_waitcnt vmcnt(4)
    buffer_load_dwordx4 v[180:183], v5, s[8:11], s54 offen offset:1024 nt
    v_dot2_f32_bf16 v48, v160, v10, 0
    v_dot2_f32_bf16 v48, v161, v11, v48
    v_dot2_f32_bf16 v48, v162, v12, v48
    v_dot2_f32_bf16 v48, v163, v13, v48
    s_waitcnt vmcnt(4)
    buffer_load_dwordx4 v[184:187], v5, s[8:11], s54 offen offset:2048 nt
    v_dot2_f32_bf16 v49, v164, v10, 0
    v_dot2_f32_bf16 v49, v165, v11, v49
    v_dot2_f32_bf16 v49, v166, v12, v49
    v_dot2_f32_bf16 v49, v167, v13, v49
    v_add_f32_dpp v50, v48, v48 row_ror:8 row_mask:0xf bank_mask:0x3
    s_nop 1
    v_add_f32_dpp v50, v49, v49 row_ror:8 row_mask:0xf bank_mask:0xc
    s_waitcnt vmcnt(4)
    buffer_load_dwordx4 v[188:191], v5, s[8:11], s54 offen offset:3072 nt
    v_dot2_f32_bf16 v48, v168, v10, 0
    v_dot2_f32_bf16 v48, v169, v11, v48
    v_dot2_f32_bf16 v48, v170, v12, v48
    v_dot2_f32_bf16 v48, v171, v13, v48
    s_waitcnt vmcnt(4)
    buffer_load_dwordx4 v[192:195], v6, s[8:11], s54 offen offset:0 nt
    v_dot2_f32_bf16 v49, v172, v10, 0
    v_dot2_f32_bf16 v49, v173, v11, v49
    v_dot2_f32_bf16 v49, v174, v12, v49
    v_dot2_f32_bf16 v49, v175, v13, v49
    v_add_f32_dpp v51, v48, v48 row_ror:8 row_mask:0xf bank_mask:0x3
    s_nop 1
    v_add_f32_dpp v51, v49, v49 row_ror:8 row_mask:0xf bank_mask:0xc
    v_add_f32_dpp v52, v50, v50 row_half_mirror row_mask:0xf bank_mask:0x5
    s_nop 0
    v_add_f32_dpp v52, v51, v51 row_half_mirror row_mask:0xf bank_mask:0xa
    s_waitcnt vmcnt(4)
    buffer_load_dwordx4 v[196:199], v6, s[8:11], s54 offen offset:1024 nt
    v_dot2_f32_bf16 v48, v176, v10, 0
    v_dot2_f32_bf16 v48, v177, v11, v48
    v_dot2_f32_bf16 v48, v178, v12, v48
    v_dot2_f32_bf16 v48, v179, v13, v48
    s_waitcnt vmcnt(4)
    buffer_load_dwordx4 v[200:203], v6, s[8:11], s54 offen offset:2048 nt
    v_dot2_f32_bf16 v49, v180, v10, 0
    v_dot2_f32_bf16 v49, v181, v11, v49
    v_dot2_f32_bf16 v49, v182, v12, v49
    v_dot2_f32_bf16 v49, v183, v13, v49
    v_add_f32_dpp v50, v48, v48 row_ror:8 row_mask:0xf bank_mask:0x3
    s_nop 1
    v_add_f32_dpp v50, v49, v49 row_ror:8 row_mask:0xf bank_mask:0xc
    s_waitcnt vmcnt(4)
    buffer_load_dwordx4 v[204:207], v6, s[8:11], s54 offen offset:3072 nt
    v_dot2_f32_bf16 v48, v184, v10, 0
    v_dot2_f32_bf16 v48, v185, v11, v48
    v_dot2_f32_bf16 v48, v186, v12, v48
    v_dot2_f32_bf16 v48, v187, v13, v48
    s_waitcnt vmcnt(4)
    buffer_load_dwordx4 v[208:211], v7, s[8:11], s54 offen offset:0 nt
    s_memrealtime s[52:53]
    v_dot2_f32_bf16 v49, v188, v10, 0
    v_dot2_f32_bf16 v49, v189, v11, v49
    v_dot2_f32_bf16 v49, v190, v12, v49
    v_dot2_f32_bf16 v49, v191, v13, v49
    v_add_f32_dpp v51, v48, v48 row_ror:8 row_mask:0xf bank_mask:0x3
    s_nop 1
    v_add_f32_dpp v51, v49, v49 row_ror:8 row_mask:0xf bank_mask:0xc
    v_add_f32_dpp v53, v50, v50 row_half_mirror row_mask:0xf bank_mask:0x5
    s_nop 0
    v_add_f32_dpp v53, v51, v51 row_half_mirror row_mask:0xf bank_mask:0xa
    v_add_f32_dpp v52, v52, v52 quad_perm:[2,3,0,1] row_mask:0xf bank_mask:0xf
    s_nop 0
    v_add_f32_dpp v53, v53, v53 quad_perm:[2,3,0,1] row_mask:0xf bank_mask:0xf
    v_cndmask_b32 v55, v52, v53, s[60:61]
    v_add_f32_dpp v54, v54, v54 quad_perm:[1,0,3,2] row_mask:0xf bank_mask:0xf
    s_nop 0
    v_add_f32_dpp v55, v55, v55 quad_perm:[1,0,3,2] row_mask:0xf bank_mask:0xf
    v_cndmask_b32 v46, v54, v55, s[62:63]
    v_cvt_pk_bf16_f32 v46, v46, v46
    v_and_b32 v46, 0xffff0000, v46
    v_mul_f32 v46, s90, v46
    v_cvt_pk_bf16_f32 v46, v46, v46
    v_and_b32 v46, 0xffff0000, v46
    v_max_f32 v64, v64, v46
L_k_mid:
    s_waitcnt lgkmcnt(0)
    s_sub_u32 s58, s52, s48
    s_lshl_b32 s58, s58, 8
    s_sub_u32 s58, s58, s49
    s_add_u32 s49, s49, s57
    s_sub_u32 s101, s58, s100
    s_cmp_gt_i32 s101, 30720
    s_cselect_b32 s101, 56320, 0
    s_add_u32 s49, s49, s101
    s_sub_u32 s58, s58, s101
    s_mov_b32 s100, s58
    s_sub_u32 s19, s19, 1
    s_cmp_ge_i32 s19, 0
    s_cselect_b32 s58, 1, s58
    s_cmp_gt_i32 s58, 0
    s_cbranch_scc1 L_k_1_6
L_k_1_5:
    s_waitcnt vmcnt(4)
    s_cmp_gt_u32 s51, 5
    s_cbranch_scc1 L_k_1_5_s16
    buffer_load_dwordx4 v[212:215], v7, s[8:11], s54 offen offset:1024 nt
L_k_1_5_s16:
    v_dot2_f32_bf16 v48, v192, v10, 0
    v_dot2_f32_bf16 v48, v193, v11, v48
    v_dot2_f32_bf16 v48, v194, v12, v48
    v_dot2_f32_bf16 v48, v195, v13, v48
    s_waitcnt vmcnt(4)
    buffer_load_dwordx4 v[216:219], v7, s[8:11], s54 offen offset:2048 nt
    s_mov_b32 s51, 5
    v_dot2_f32_bf16 v49, v196, v10, 0
    v_dot2_f32_bf16 v49, v197, v11, v49
    v_dot2_f32_bf16 v49, v198, v12, v49
    v_dot2_f32_bf16 v49, v199, v13, v49
    v_add_f32_dpp v50, v48, v48 row_ror:8 row_mask:0xf bank_mask:0x3
    s_nop 1
    v_add_f32_dpp v50, v49, v49 row_ror:8 row_mask:0xf bank_mask:0xc
    s_waitcnt vmcnt(4)
    buffer_load_dwordx4 v[220:223], v7, s[8:11], s54 offen offset:3072 nt
    v_dot2_f32_bf16 v48, v200, v10, 0
    v_dot2_f32_bf16 v48, v201, v11, v48
    v_dot2_f32_bf16 v48, v202, v12, v48
    v_dot2_f32_bf16 v48, v203, v13, v48
    s_waitcnt vmcnt(4)
    buffer_load_dwordx4 v[224:227], v8, s[8:11], s54 offen offset:0 nt
    v_dot2_f32_bf16 v49, v204, v10, 0
    v_dot2_f32_bf16 v49, v205, v11, v49
    v_dot2_f32_bf16 v49, v206, v12, v49
    v_dot2_f32_bf16 v49, v207, v13, v49
    v_add_f32_dpp v51, v48, v48 row_ror:8 row_mask:0xf bank_mask:0x3
    s_nop 1
    v_add_f32_dpp v51, v49, v49 row_ror:8 row_mask:0xf bank_mask:0xc
    v_add_f32_dpp v52, v50, v50 row_half_mirror row_mask:0xf bank_mask:0x5
    s_nop 0
    v_add_f32_dpp v52, v51, v51 row_half_mirror row_mask:0xf bank_mask:0xa
    s_waitcnt vmcnt(4)
    buffer_load_dwordx4 v[228:231], v8, s[8:11], s54 offen offset:1024 nt
    v_dot2_f32_bf16 v48, v208, v10, 0
    v_dot2_f32_bf16 v48, v209, v11, v48
    v_dot2_f32_bf16 v48, v210, v12, v48
    v_dot2_f32_bf16 v48, v211, v13, v48
    s_waitcnt vmcnt(4)
    buffer_load_dwordx4 v[232:235], v8, s[8:11], s54 offen offset:2048 nt
    v_dot2_f32_bf16 v49, v212, v10, 0
    v_dot2_f32_bf16 v49, v213, v11, v49
    v_dot2_f32_bf16 v49, v214, v12, v49
    v_dot2_f32_bf16 v49, v215, v13, v49
    v_add_f32_dpp v50, v48, v48 row_ror:8 row_mask:0xf bank_mask:0x3
    s_nop 1
    v_add_f32_dpp v50, v49, v49 row_ror:8 row_mask:0xf bank_mask:0xc
    s_waitcnt vmcnt(4)
    buffer_load_dwordx4 v[236:239], v8, s[8:11], s54 offen offset:3072 nt
    v_dot2_f32_bf16 v48, v216, v10, 0
    v_dot2_f32_bf16 v48, v217, v11, v48
    v_dot2_f32_bf16 v48, v218, v12, v48
    v_dot2_f32_bf16 v48, v219, v13, v48
    s_waitcnt vmcnt(4)
    buffer_load_dwordx4 v[240:243], v9, s[8:11], s54 offen offset:0 nt
    v_dot2_f32_bf16 v49, v220, v10, 0
    v_dot2_f32_bf16 v49, v221, v11, v49
    v_dot2_f32_bf16 v49, v222, v12, v49
    v_dot2_f32_bf16 v49, v223, v13, v49
    v_add_f32_dpp v51, v48, v48 row_ror:8 row_mask:0xf bank_mask:0x3
    s_nop 1
    v_add_f32_dpp v51, v49, v49 row_ror:8 row_mask:0xf bank_mask:0xc
    v_add_f32_dpp v53, v50, v50 row_half_mirror row_mask:0xf bank_mask:0x5
    s_nop 0
    v_add_f32_dpp v53, v51, v51 row_half_mirror row_mask:0xf bank_mask:0xa
    v_add_f32_dpp v52, v52, v52 quad_perm:[2,3,0,1] row_mask:0xf bank_mask:0xf
    s_nop 0
    v_add_f32_dpp v53, v53, v53 quad_perm:[2,3,0,1] row_mask:0xf bank_mask:0xf
    v_cndmask_b32 v54, v52, v53, s[60:61]
    s_waitcnt vmcnt(4)
    buffer_load_dwordx4 v[244:247], v9, s[8:11], s54 offen offset:1024 nt
    v_dot2_f32_bf16 v48, v224, v10, 0
    v_dot2_f32_bf16 v48, v225, v11, v48
    v_dot2_f32_bf16 v48, v226, v12, v48
    v_dot2_f32_bf16 v48, v227, v13, v48
    s_waitcnt vmcnt(4)
    buffer_load_dwordx4 v[248:251], v9, s[8:11], s54 offen offset:2048 nt
    v_dot2_f32_bf16 v49, v228, v10, 0
    v_dot2_f32_bf16 v49, v229, v11, v49
    v_dot2_f32_bf16 v49, v230, v12, v49
    v_dot2_f32_bf16 v49, v231, v13, v49
    v_add_f32_dpp v50, v48, v48 row_ror:8 row_mask:0xf bank_mask:0x3
    s_nop 1
    v_add_f32_dpp v50, v49, v49 row_ror:8 row_mask:0xf bank_mask:0xc
    s_waitcnt vmcnt(4)
    buffer_load_dwordx4 v[252:255], v9, s[8:11], s54 offen offset:3072 nt
    v_dot2_f32_bf16 v48, v232, v10, 0
    v_dot2_f32_bf16 v48, v233, v11, v48
    v_dot2_f32_bf16 v48, v234, v12, v48
    v_dot2_f32_bf16 v48, v235, v13, v48
    s_waitcnt vmcnt(4)
    buffer_load_dwordx4 v[128:131], v2, s[12:15], s55 offen offset:0 nt
    v_dot2_f32_bf16 v49, v236, v10, 0
    v_dot2_f32_bf16 v49, v237, v11, v49
    v_dot2_f32_bf16 v49, v238, v12, v49
    v_dot2_f32_bf16 v49, v239, v13, v49
    v_add_f32_dpp v51, v48, v48 row_ror:8 row_mask:0xf bank_mask:0x3
    s_nop 1
    v_add_f32_dpp v51, v49, v49 row_ror:8 row_mask:0xf bank_mask:0xc
    v_add_f32_dpp v52, v50, v50 row_half_mirror row_mask:0xf bank_mask:0x5
    s_nop 0
    v_add_f32_dpp v52, v51, v51 row_half_mirror row_mask:0xf bank_mask:0xa
    s_waitcnt vmcnt(4)
    buffer_load_dwordx4 v[132:135], v2, s[12:15], s55 offen offset:1024 nt
    v_dot2_f32_bf16 v48, v240, v10, 0
    v_dot2_f32_bf16 v48, v241, v11, v48
    v_dot2_f32_bf16 v48, v242, v12, v48
    v_dot2_f32_bf16 v48, v243, v13, v48
    s_waitcnt vmcnt(4)
    buffer_load_dwordx4 v[136:139], v2, s[12:15], s55 offen offset:2048 nt
    v_dot2_f32_bf16 v49, v244, v10, 0
    v_dot2_f32_bf16 v49, v245, v11, v49
    v_dot2_f32_bf16 v49, v246, v12, v49
    v_dot2_f32_bf16 v49, v247, v13, v49
    v_add_f32_dpp v50, v48, v48 row_ror:8 row_mask:0xf bank_mask:0x3
    s_nop 1
    v_add_f32_dpp v50, v49, v49 row_ror:8 row_mask:0xf bank_mask:0xc
    s_waitcnt vmcnt(4)
    buffer_load_dwordx4 v[140:143], v2, s[12:15], s55 offen offset:3072 nt
    v_dot2_f32_bf16 v48, v248, v10, 0
    v_dot2_f32_bf16 v48, v249, v11, v48
    v_dot2_f32_bf16 v48, v250, v12, v48
    v_dot2_f32_bf16 v48, v251, v13, v48
    s_waitcnt vmcnt(4)
    buffer_load_dwordx4 v[144:147], v3, s[12:15], s55 offen offset:0 nt
    s_memrealtime s[52:53]
    v_dot2_f32_bf16 v49, v252, v10, 0
    v_dot2_f32_bf16 v49, v253, v11, v49
    v_dot2_f32_bf16 v49, v254, v12, v49
    v_dot2_f32_bf16 v49, v255, v13, v49
    v_add_f32_dpp v51, v48, v48 row_ror:8 row_mask:0xf bank_mask:0x3
    s_nop 1
    v_add_f32_dpp v51, v49, v49 row_ror:8 row_mask:0xf bank_mask:0xc
    v_add_f32_dpp v53, v50, v50 row_half_mirror row_mask:0xf bank_mask:0x5
    s_nop 0
    v_add_f32_dpp v53, v51, v51 row_half_mirror row_mask:0xf bank_mask:0xa
    v_add_f32_dpp v52, v52, v52 quad_perm:[2,3,0,1] row_mask:0xf bank_mask:0xf
    s_nop 0
    v_add_f32_dpp v53, v53, v53 quad_perm:[2,3,0,1] row_mask:0xf bank_mask:0xf
    v_cndmask_b32 v55, v52, v53, s[60:61]
    v_add_f32_dpp v54, v54, v54 quad_perm:[1,0,3,2] row_mask:0xf bank_mask:0xf
    s_nop 0
    v_add_f32_dpp v55, v55, v55 quad_perm:[1,0,3,2] row_mask:0xf bank_mask:0xf
    v_cndmask_b32 v47, v54, v55, s[62:63]
    v_cvt_pk_bf16_f32 v47, v47, v47
    v_and_b32 v47, 0xffff0000, v47
    v_mul_f32 v47, s90, v47
    v_cvt_pk_bf16_f32 v47, v47, v47
    v_and_b32 v47, 0xffff0000, v47
    v_max_f32 v64, v64, v47
L_k_nxt:
    s_add_u32 s56, s56, 1
    s_cmp_lt_u32 s56, 8
    s_cbranch_scc1 L_k
    s_branch L_k_end
L_k_0_6:
    s_cmp_gt_u32 s51, 5
    s_cbranch_scc1 L_k_0_6_i5
    buffer_load_dwordx4 v[148:151], v3, s[8:11], s54 offen offset:1024 nt
L_k_0_6_i5:
    s_waitcnt vmcnt(5)
    buffer_load_dwordx4 v[152:155], v3, s[8:11], s54 offen offset:2048 nt
    s_mov_b32 s51, 6
    v_dot2_f32_bf16 v48, v128, v10, 0
    v_dot2_f32_bf16 v48, v129, v11, v48
    v_dot2_f32_bf16 v48, v130, v12, v48
    v_dot2_f32_bf16 v48, v131, v13, v48
    s_waitcnt vmcnt(5)
    buffer_load_dwordx4 v[156:159], v3, s[8:11], s54 offen offset:3072 nt
    v_dot2_f32_bf16 v49, v132, v10, 0
    v_dot2_f32_bf16 v49, v133, v11, v49
    v_dot2_f32_bf16 v49, v134, v12, v49
    v_dot2_f32_bf16 v49, v135, v13, v49
    v_add_f32_dpp v50, v48, v48 row_ror:8 row_mask:0xf bank_mask:0x3
    s_nop 1
    v_add_f32_dpp v50, v49, v49 row_ror:8 row_mask:0xf bank_mask:0xc
    s_waitcnt vmcnt(5)
    buffer_load_dwordx4 v[160:163], v4, s[8:11], s54 offen offset:0 nt
    v_dot2_f32_bf16 v48, v136, v10, 0
    v_dot2_f32_bf16 v48, v137, v11, v48
    v_dot2_f32_bf16 v48, v138, v12, v48
    v_dot2_f32_bf16 v48, v139, v13, v48
    s_waitcnt vmcnt(5)
    buffer_load_dwordx4 v[164:167], v4, s[8:11], s54 offen offset:1024 nt
    v_dot2_f32_bf16 v49, v140, v10, 0
    v_dot2_f32_bf16 v49, v141, v11, v49
    v_dot2_f32_bf16 v49, v142, v12, v49
    v_dot2_f32_bf16 v49, v143, v13, v49
    v_add_f32_dpp v51, v48, v48 row_ror:8 row_mask:0xf bank_mask:0x3
    s_nop 1
    v_add_f32_dpp v51, v49, v49 row_ror:8 row_mask:0xf bank_mask:0xc
    v_add_f32_dpp v52, v50, v50 row_half_mirror row_mask:0xf bank_mask:0x5
    s_nop 0
    v_add_f32_dpp v52, v51, v51 row_half_mirror row_mask:0xf bank_mask:0xa
    s_waitcnt vmcnt(5)
    buffer_load_dwordx4 v[168:171], v4, s[8:11], s54 offen offset:2048 nt
    v_dot2_f32_bf16 v48, v144, v10, 0
    v_dot2_f32_bf16 v48, v145, v11, v48
    v_dot2_f32_bf16 v48, v146, v12, v48
    v_dot2_f32_bf16 v48, v147, v13, v48
    s_waitcnt vmcnt(5)
    buffer_load_dwordx4 v[172:175], v4, s[8:11], s54 offen offset:3072 nt
    v_dot2_f32_bf16 v49, v148, v10, 0
    v_dot2_f32_bf16 v49, v149, v11, v49
    v_dot2_f32_bf16 v49, v150, v12, v49
    v_dot2_f32_bf16 v49, v151, v13, v49
    v_add_f32_dpp v50, v48, v48 row_ror:8 row_mask:0xf bank_mask:0x3
    s_nop 1
    v_add_f32_dpp v50, v49, v49 row_ror:8 row_mask:0xf bank_mask:0xc
    s_waitcnt vmcnt(5)
    buffer_load_dwordx4 v[176:179], v5, s[8:11], s54 offen offset:0 nt
    v_dot2_f32_bf16 v48, v152, v10, 0
    v_dot2_f32_bf16 v48, v153, v11, v48
    v_dot2_f32_bf16 v48, v154, v12, v48
    v_dot2_f32_bf16 v48, v155, v13, v48
    s_waitcnt vmcnt(5)
    buffer_load_dwordx4 v[180:183], v5, s[8:11], s54 offen offset:1024 nt
    v_dot2_f32_bf16 v49, v156, v10, 0
    v_dot2_f32_bf16 v49, v157, v11, v49
    v_dot2_f32_bf16 v49, v158, v12, v49
    v_dot2_f32_bf16 v49, v159, v13, v49
    v_add_f32_dpp v51, v48, v48 row_ror:8 row_mask:0xf bank_mask:0x3
    s_nop 1
    v_add_f32_dpp v51, v49, v49 row_ror:8 row_mask:0xf bank_mask:0xc
    v_add_f32_dpp v53, v50, v50 row_half_mirror row_mask:0xf bank_mask:0x5
    s_nop 0
    v_add_f32_dpp v53, v51, v51 row_half_mirror row_mask:0xf bank_mask:0xa
    v_add_f32_dpp v52, v52, v52 quad_perm:[2,3,0,1] row_mask:0xf bank_mask:0xf
    s_nop 0
    v_add_f32_dpp v53, v53, v53 quad_perm:[2,3,0,1] row_mask:0xf bank_mask:0xf
    v_cndmask_b32 v54, v52, v53, s[60:61]
    s_waitcnt vmcnt(5)
    buffer_load_dwordx4 v[184:187], v5, s[8:11], s54 offen offset:2048 nt
    v_dot2_f32_bf16 v48, v160, v10, 0
    v_dot2_f32_bf16 v48, v161, v11, v48
    v_dot2_f32_bf16 v48, v162, v12, v48
    v_dot2_f32_bf16 v48, v163, v13, v48
    s_waitcnt vmcnt(5)
    buffer_load_dwordx4 v[188:191], v5, s[8:11], s54 offen offset:3072 nt
    v_dot2_f32_bf16 v49, v164, v10, 0
    v_dot2_f32_bf16 v49, v165, v11, v49
    v_dot2_f32_bf16 v49, v166, v12, v49
    v_dot2_f32_bf16 v49, v167, v13, v49
    v_add_f32_dpp v50, v48, v48 row_ror:8 row_mask:0xf bank_mask:0x3
    s_nop 1
    v_add_f32_dpp v50, v49, v49 row_ror:8 row_mask:0xf bank_mask:0xc
    s_waitcnt vmcnt(5)
    buffer_load_dwordx4 v[192:195], v6, s[8:11], s54 offen offset:0 nt
    v_dot2_f32_bf16 v48, v168, v10, 0
    v_dot2_f32_bf16 v48, v169, v11, v48
    v_dot2_f32_bf16 v48, v170, v12, v48
    v_dot2_f32_bf16 v48, v171, v13, v48
    s_waitcnt vmcnt(5)
    buffer_load_dwordx4 v[196:199], v6, s[8:11], s54 offen offset:1024 nt
    v_dot2_f32_bf16 v49, v172, v10, 0
    v_dot2_f32_bf16 v49, v173, v11, v49
    v_dot2_f32_bf16 v49, v174, v12, v49
    v_dot2_f32_bf16 v49, v175, v13, v49
    v_add_f32_dpp v51, v48, v48 row_ror:8 row_mask:0xf bank_mask:0x3
    s_nop 1
    v_add_f32_dpp v51, v49, v49 row_ror:8 row_mask:0xf bank_mask:0xc
    v_add_f32_dpp v52, v50, v50 row_half_mirror row_mask:0xf bank_mask:0x5
    s_nop 0
    v_add_f32_dpp v52, v51, v51 row_half_mirror row_mask:0xf bank_mask:0xa
    s_waitcnt vmcnt(5)
    buffer_load_dwordx4 v[200:203], v6, s[8:11], s54 offen offset:2048 nt
    v_dot2_f32_bf16 v48, v176, v10, 0
    v_dot2_f32_bf16 v48, v177, v11, v48
    v_dot2_f32_bf16 v48, v178, v12, v48
    v_dot2_f32_bf16 v48, v179, v13, v48
    s_waitcnt vmcnt(5)
    buffer_load_dwordx4 v[204:207], v6, s[8:11], s54 offen offset:3072 nt
    v_dot2_f32_bf16 v49, v180, v10, 0
    v_dot2_f32_bf16 v49, v181, v11, v49
    v_dot2_f32_bf16 v49, v182, v12, v49
    v_dot2_f32_bf16 v49, v183, v13, v49
    v_add_f32_dpp v50, v48, v48 row_ror:8 row_mask:0xf bank_mask:0x3
    s_nop 1
    v_add_f32_dpp v50, v49, v49 row_ror:8 row_mask:0xf bank_mask:0xc
    s_waitcnt vmcnt(5)
    buffer_load_dwordx4 v[208:211], v7, s[8:11], s54 offen offset:0 nt
    v_dot2_f32_bf16 v48, v184, v10, 0
    v_dot2_f32_bf16 v48, v185, v11, v48
    v_dot2_f32_bf16 v48, v186, v12, v48
    v_dot2_f32_bf16 v48, v187, v13, v48
    s_waitcnt vmcnt(5)
    buffer_load_dwordx4 v[212:215], v7, s[8:11], s54 offen offset:1024 nt
    s_memrealtime s[52:53]
    v_dot2_f32_bf16 v49, v188, v10, 0
    v_dot2_f32_bf16 v49, v189, v11, v49
    v_dot2_f32_bf16 v49, v190, v12, v49
    v_dot2_f32_bf16 v49, v191, v13, v49
    v_add_f32_dpp v51, v48, v48 row_ror:8 row_mask:0xf bank_mask:0x3
    s_nop 1
    v_add_f32_dpp v51, v49, v49 row_ror:8 row_mask:0xf bank_mask:0xc
    v_add_f32_dpp v53, v50, v50 row_half_mirror row_mask:0xf bank_mask:0x5
    s_nop 0
    v_add_f32_dpp v53, v51, v51 row_half_mirror row_mask:0xf bank_mask:0xa
    v_add_f32_dpp v52, v52, v52 quad_perm:[2,3,0,1] row_mask:0xf bank_mask:0xf
    s_nop 0
    v_add_f32_dpp v53, v53, v53 quad_perm:[2,3,0,1] row_mask:0xf bank_mask:0xf
    v_cndmask_b32 v55, v52, v53, s[60:61]
    v_add_f32_dpp v54, v54, v54 quad_perm:[1,0,3,2] row_mask:0xf bank_mask:0xf
    s_nop 0
    v_add_f32_dpp v55, v55, v55 quad_perm:[1,0,3,2] row_mask:0xf bank_mask:0xf
    v_cndmask_b32 v46, v54, v55, s[62:63]
    v_cvt_pk_bf16_f32 v46, v46, v46
    v_and_b32 v46, 0xffff0000, v46
    v_mul_f32 v46, s90, v46
    v_cvt_pk_bf16_f32 v46, v46, v46
    v_and_b32 v46, 0xffff0000, v46
    v_max_f32 v64, v64, v46
    s_branch L_k_mid
L_k_1_6:
    s_cmp_gt_u32 s51, 5
    s_cbranch_scc1 L_k_1_6_i5
    buffer_load_dwordx4 v[212:215], v7, s[8:11], s54 offen offset:1024 nt
L_k_1_6_i5:
    s_waitcnt vmcnt(5)
    buffer_load_dwordx4 v[216:219], v7, s[8:11], s54 offen offset:2048 nt
    s_mov_b32 s51, 6
    v_dot2_f32_bf16 v48, v192, v10, 0
    v_dot2_f32_bf16 v48, v193, v11, v48
    v_dot2_f32_bf16 v48, v194, v12, v48
    v_dot2_f32_bf16 v48, v195, v13, v48
    s_waitcnt vmcnt(5)
    buffer_load_dwordx4 v[220:223], v7, s[8:11], s54 offen offset:3072 nt
    v_dot2_f32_bf16 v49, v196, v10, 0
    v_dot2_f32_bf16 v49, v197, v11, v49
    v_dot2_f32_bf16 v49, v198, v12, v49
    v_dot2_f32_bf16 v49, v199, v13, v49
    v_add_f32_dpp v50, v48, v48 row_ror:8 row_mask:0xf bank_mask:0x3
    s_nop 1
    v_add_f32_dpp v50, v49, v49 row_ror:8 row_mask:0xf bank_mask:0xc
    s_waitcnt vmcnt(5)
    buffer_load_dwordx4 v[224:227], v8, s[8:11], s54 offen offset:0 nt
    v_dot2_f32_bf16 v48, v200, v10, 0
    v_dot2_f32_bf16 v48, v201, v11, v48
    v_dot2_f32_bf16 v48, v202, v12, v48
    v_dot2_f32_bf16 v48, v203, v13, v48
    s_waitcnt vmcnt(5)
    buffer_load_dwordx4 v[228:231], v8, s[8:11], s54 offen offset:1024 nt
    v_dot2_f32_bf16 v49, v204, v10, 0
    v_dot2_f32_bf16 v49, v205, v11, v49
    v_dot2_f32_bf16 v49, v206, v12, v49
    v_dot2_f32_bf16 v49, v207, v13, v49
    v_add_f32_dpp v51, v48, v48 row_ror:8 row_mask:0xf bank_mask:0x3
    s_nop 1
    v_add_f32_dpp v51, v49, v49 row_ror:8 row_mask:0xf bank_mask:0xc
    v_add_f32_dpp v52, v50, v50 row_half_mirror row_mask:0xf bank_mask:0x5
    s_nop 0
    v_add_f32_dpp v52, v51, v51 row_half_mirror row_mask:0xf bank_mask:0xa
    s_waitcnt vmcnt(5)
    buffer_load_dwordx4 v[232:235], v8, s[8:11], s54 offen offset:2048 nt
    v_dot2_f32_bf16 v48, v208, v10, 0
    v_dot2_f32_bf16 v48, v209, v11, v48
    v_dot2_f32_bf16 v48, v210, v12, v48
    v_dot2_f32_bf16 v48, v211, v13, v48
    s_waitcnt vmcnt(5)
    buffer_load_dwordx4 v[236:239], v8, s[8:11], s54 offen offset:3072 nt
    v_dot2_f32_bf16 v49, v212, v10, 0
    v_dot2_f32_bf16 v49, v213, v11, v49
    v_dot2_f32_bf16 v49, v214, v12, v49
    v_dot2_f32_bf16 v49, v215, v13, v49
    v_add_f32_dpp v50, v48, v48 row_ror:8 row_mask:0xf bank_mask:0x3
    s_nop 1
    v_add_f32_dpp v50, v49, v49 row_ror:8 row_mask:0xf bank_mask:0xc
    s_waitcnt vmcnt(5)
    buffer_load_dwordx4 v[240:243], v9, s[8:11], s54 offen offset:0 nt
    v_dot2_f32_bf16 v48, v216, v10, 0
    v_dot2_f32_bf16 v48, v217, v11, v48
    v_dot2_f32_bf16 v48, v218, v12, v48
    v_dot2_f32_bf16 v48, v219, v13, v48
    s_waitcnt vmcnt(5)
    buffer_load_dwordx4 v[244:247], v9, s[8:11], s54 offen offset:1024 nt
    v_dot2_f32_bf16 v49, v220, v10, 0
    v_dot2_f32_bf16 v49, v221, v11, v49
    v_dot2_f32_bf16 v49, v222, v12, v49
    v_dot2_f32_bf16 v49, v223, v13, v49
    v_add_f32_dpp v51, v48, v48 row_ror:8 row_mask:0xf bank_mask:0x3
    s_nop 1
    v_add_f32_dpp v51, v49, v49 row_ror:8 row_mask:0xf bank_mask:0xc
    v_add_f32_dpp v53, v50, v50 row_half_mirror row_mask:0xf bank_mask:0x5
    s_nop 0
    v_add_f32_dpp v53, v51, v51 row_half_mirror row_mask:0xf bank_mask:0xa
    v_add_f32_dpp v52, v52, v52 quad_perm:[2,3,0,1] row_mask:0xf bank_mask:0xf
    s_nop 0
    v_add_f32_dpp v53, v53, v53 quad_perm:[2,3,0,1] row_mask:0xf bank_mask:0xf
    v_cndmask_b32 v54, v52, v53, s[60:61]
    s_waitcnt vmcnt(5)
    buffer_load_dwordx4 v[248:251], v9, s[8:11], s54 offen offset:2048 nt
    v_dot2_f32_bf16 v48, v224, v10, 0
    v_dot2_f32_bf16 v48, v225, v11, v48
    v_dot2_f32_bf16 v48, v226, v12, v48
    v_dot2_f32_bf16 v48, v227, v13, v48
    s_waitcnt vmcnt(5)
    buffer_load_dwordx4 v[252:255], v9, s[8:11], s54 offen offset:3072 nt
    v_dot2_f32_bf16 v49, v228, v10, 0
    v_dot2_f32_bf16 v49, v229, v11, v49
    v_dot2_f32_bf16 v49, v230, v12, v49
    v_dot2_f32_bf16 v49, v231, v13, v49
    v_add_f32_dpp v50, v48, v48 row_ror:8 row_mask:0xf bank_mask:0x3
    s_nop 1
    v_add_f32_dpp v50, v49, v49 row_ror:8 row_mask:0xf bank_mask:0xc
    s_waitcnt vmcnt(5)
    buffer_load_dwordx4 v[128:131], v2, s[12:15], s55 offen offset:0 nt
    v_dot2_f32_bf16 v48, v232, v10, 0
    v_dot2_f32_bf16 v48, v233, v11, v48
    v_dot2_f32_bf16 v48, v234, v12, v48
    v_dot2_f32_bf16 v48, v235, v13, v48
    s_waitcnt vmcnt(5)
    buffer_load_dwordx4 v[132:135], v2, s[12:15], s55 offen offset:1024 nt
    v_dot2_f32_bf16 v49, v236, v10, 0
    v_dot2_f32_bf16 v49, v237, v11, v49
    v_dot2_f32_bf16 v49, v238, v12, v49
    v_dot2_f32_bf16 v49, v239, v13, v49
    v_add_f32_dpp v51, v48, v48 row_ror:8 row_mask:0xf bank_mask:0x3
    s_nop 1
    v_add_f32_dpp v51, v49, v49 row_ror:8 row_mask:0xf bank_mask:0xc
    v_add_f32_dpp v52, v50, v50 row_half_mirror row_mask:0xf bank_mask:0x5
    s_nop 0
    v_add_f32_dpp v52, v51, v51 row_half_mirror row_mask:0xf bank_mask:0xa
    s_waitcnt vmcnt(5)
    buffer_load_dwordx4 v[136:139], v2, s[12:15], s55 offen offset:2048 nt
    v_dot2_f32_bf16 v48, v240, v10, 0
    v_dot2_f32_bf16 v48, v241, v11, v48
    v_dot2_f32_bf16 v48, v242, v12, v48
    v_dot2_f32_bf16 v48, v243, v13, v48
    s_waitcnt vmcnt(5)
    buffer_load_dwordx4 v[140:143], v2, s[12:15], s55 offen offset:3072 nt
    v_dot2_f32_bf16 v49, v244, v10, 0
    v_dot2_f32_bf16 v49, v245, v11, v49
    v_dot2_f32_bf16 v49, v246, v12, v49
    v_dot2_f32_bf16 v49, v247, v13, v49
    v_add_f32_dpp v50, v48, v48 row_ror:8 row_mask:0xf bank_mask:0x3
    s_nop 1
    v_add_f32_dpp v50, v49, v49 row_ror:8 row_mask:0xf bank_mask:0xc
    s_waitcnt vmcnt(5)
    buffer_load_dwordx4 v[144:147], v3, s[12:15], s55 offen offset:0 nt
    v_dot2_f32_bf16 v48, v248, v10, 0
    v_dot2_f32_bf16 v48, v249, v11, v48
    v_dot2_f32_bf16 v48, v250, v12, v48
    v_dot2_f32_bf16 v48, v251, v13, v48
    s_waitcnt vmcnt(5)
    buffer_load_dwordx4 v[148:151], v3, s[12:15], s55 offen offset:1024 nt
    s_memrealtime s[52:53]
    v_dot2_f32_bf16 v49, v252, v10, 0
    v_dot2_f32_bf16 v49, v253, v11, v49
    v_dot2_f32_bf16 v49, v254, v12, v49
    v_dot2_f32_bf16 v49, v255, v13, v49
    v_add_f32_dpp v51, v48, v48 row_ror:8 row_mask:0xf bank_mask:0x3
    s_nop 1
    v_add_f32_dpp v51, v49, v49 row_ror:8 row_mask:0xf bank_mask:0xc
    v_add_f32_dpp v53, v50, v50 row_half_mirror row_mask:0xf bank_mask:0x5
    s_nop 0
    v_add_f32_dpp v53, v51, v51 row_half_mirror row_mask:0xf bank_mask:0xa
    v_add_f32_dpp v52, v52, v52 quad_perm:[2,3,0,1] row_mask:0xf bank_mask:0xf
    s_nop 0
    v_add_f32_dpp v53, v53, v53 quad_perm:[2,3,0,1] row_mask:0xf bank_mask:0xf
    v_cndmask_b32 v55, v52, v53, s[60:61]
    v_add_f32_dpp v54, v54, v54 quad_perm:[1,0,3,2] row_mask:0xf bank_mask:0xf
    s_nop 0
    v_add_f32_dpp v55, v55, v55 quad_perm:[1,0,3,2] row_mask:0xf bank_mask:0xf
    v_cndmask_b32 v47, v54, v55, s[62:63]
    v_cvt_pk_bf16_f32 v47, v47, v47
    v_and_b32 v47, 0xffff0000, v47
    v_mul_f32 v47, s90, v47
    v_cvt_pk_bf16_f32 v47, v47, v47
    v_and_b32 v47, 0xffff0000, v47
    v_max_f32 v64, v64, v47
    s_branch L_k_nxt
L_k_end:
    s_nop 0
    v_max_f32_dpp v64, v64, v64 row_ror:8 row_mask:0xf bank_mask:0xf
    s_nop 1
    v_max_f32_dpp v64, v64, v64 row_ror:4 row_mask:0xf bank_mask:0xf
    s_nop 1
    v_max_f32_dpp v64, v64, v64 row_ror:2 row_mask:0xf bank_mask:0xf
    s_nop 1
    v_max_f32_dpp v64, v64, v64 row_ror:1 row_mask:0xf bank_mask:0xf
    v_mov_b32 v48, v64
    s_nop 1
    v_permlane16_swap_b32 v64, v48
    v_max_f32 v64, v64, v48
    v_mov_b32 v48, v64
    s_nop 1
    v_permlane32_swap_b32 v64, v48
    v_max_f32 v64, v64, v48
    v_mul_f32 v64, s91, v64
    v_sub_f32 v64, 0, v64
    s_mov_b32 s8, s12
    s_mov_b32 s9, s13
    s_mov_b32 s56, 0
    v_mov_b32 v28, 0
    v_mov_b32 v29, 0
    v_mov_b32 v30, 0
    v_mov_b32 v31, 0
    s_mov_b32 s20, s80
    s_mov_b32 s21, s81
    s_mov_b32 s22, 1835008
    s_mov_b32 s23, 0x20000
    s_lshr_b32 s98, s2, 3
    s_lshl_b32 s98, s98, 2
    s_add_u32 s98, s98, s3
    s_mul_i32 s96, s98, 14336
    s_add_u32 s97, s96, 7168
    s_mul_i32 s98, s98, 14336
    s_add_u32 s99, s98, 8192
    s_and_b32 s58, s2, 7
    s_mul_i32 s92, s58, 448
    s_and_b32 s92, s92, 0xff80
    s_lshl_b32 s58, s58, 7
    v_lshrrev_b32 v58, 5, v1
    v_mul_u32_u24 v58, 3584, v58
    v_and_b32 v59, 31, v1
    v_lshl_add_u32 v58, v59, 4, v58
    v_add_u32 v58, s92, v58
    v_lshrrev_b32 v59, 3, v1
    v_lshlrev_b32 v59, 10, v59
    v_and_b32 v48, 7, v1
    v_lshl_add_u32 v59, v48, 4, v59
    v_add_u32 v59, s58, v59
.p2align 3
L_v:
    s_mov_b32 s54, s55
    s_add_u32 s55, s55, 131072
    v_fma_f32 v56, v32, s91, v64
    v_exp_f32 v56, v56
    s_nop 0
    v_add_f32 v65, v65, v56
    v_cvt_pk_bf16_f32 v66, v56, v56
    v_fma_f32 v57, v33, s91, v64
    v_exp_f32 v57, v57
    s_nop 0
    v_add_f32 v65, v65, v57
    v_cvt_pk_bf16_f32 v67, v57, v57
    v_mov_b32 v32, v34
    v_mov_b32 v33, v35
    v_mov_b32 v34, v36
    v_mov_b32 v35, v37
    v_mov_b32 v36, v38
    v_mov_b32 v37, v39
    v_mov_b32 v38, v40
    v_mov_b32 v39, v41
    v_mov_b32 v40, v42
    v_mov_b32 v41, v43
    v_mov_b32 v42, v44
    v_mov_b32 v43, v45
    v_mov_b32 v44, v46
    v_mov_b32 v45, v47
    v_and_b32_dpp v18, v66, v14 row_newbcast:0 row_mask:0xf bank_mask:0xf
    v_and_b32_dpp v19, v66, v15 row_newbcast:0 row_mask:0xf bank_mask:0xf
    v_and_b32_dpp v20, v66, v16 row_newbcast:0 row_mask:0xf bank_mask:0xf
    v_and_b32_dpp v21, v66, v17 row_newbcast:0 row_mask:0xf bank_mask:0xf
    s_cmp_lg_u32 s50, 0
    s_cbranch_scc0 L_nocalV
    v_cmp_eq_u32 vcc, 0, v72
    s_cbranch_vccz L_calV
    v_lshlrev_b32 v60, 2, v1
    global_load_dword v72, v60, s[84:85] sc1
    s_branch L_nocalV
L_calV:
    s_mov_b32 s50, 0
    s_waitcnt lgkmcnt(0)
    s_mov_b32 s100, 0x20000000
    s_mov_b32 s48, s52
    v_bfe_u32 v60, v72, 16, 15
    v_subrev_u32 v61, s52, v72
    v_bfe_i32 v61, v61, 0, 16
    v_add_u32_dpp v60, v60, v60 row_ror:8 row_mask:0xf bank_mask:0xf
    s_nop 1
    v_add_u32_dpp v60, v60, v60 row_ror:4 row_mask:0xf bank_mask:0xf
    s_nop 1
    v_add_u32_dpp v60, v60, v60 row_ror:2 row_mask:0xf bank_mask:0xf
    s_nop 1
    v_add_u32_dpp v60, v60, v60 row_ror:1 row_mask:0xf bank_mask:0xf
    v_mov_b32 v62, v60
    s_nop 1
    v_permlane16_swap_b32 v60, v62
    v_add_u32 v60, v60, v62
    v_mov_b32 v62, v60
    s_nop 1
    v_permlane32_swap_b32 v60, v62
    v_add_u32 v60, v60, v62
    v_add_u32_dpp v61, v61, v61 row_ror:8 row_mask:0xf bank_mask:0xf
    s_nop 1
    v_add_u32_dpp v61, v61, v61 row_ror:4 row_mask:0xf bank_mask:0xf
    s_nop 1
    v_add_u32_dpp v61, v61, v61 row_ror:2 row_mask:0xf bank_mask:0xf
    s_nop 1
    v_add_u32_dpp v61, v61, v61 row_ror:1 row_mask:0xf bank_mask:0xf
    v_mov_b32 v62, v61
    s_nop 1
    v_permlane16_swap_b32 v61, v62
    v_add_u32 v61, v61, v62
    v_mov_b32 v62, v61
    s_nop 1
    v_permlane32_swap_b32 v61, v62
    v_add_u32 v61, v61, v62
    v_readfirstlane_b32 s57, v60
    v_readfirstlane_b32 s49, v61
    s_add_u32 s58, s56, 3
    s_lshl_b32 s58, s58, 1
    s_mul_i32 s58, s58, s57
    s_lshl_b32 s49, s49, 2
    s_add_u32 s49, s49, s58
    s_mov_b32 s58, 20480
    s_cmp_eq_u32 s7, 1
    s_cselect_b32 s58, 5120, s58
    s_cmp_eq_u32 s7, 3
    s_cselect_b32 s58, 0, s58
    s_add_u32 s49, s49, s58
L_nocalV:
    s_cmp_eq_u32 s56, 7
    s_cbranch_scc0 L_nolast
    v_add_f32_dpp v65, v65, v65 row_ror:8 row_mask:0xf bank_mask:0xf
    s_nop 1
    v_add_f32_dpp v65, v65, v65 row_ror:4 row_mask:0xf bank_mask:0xf
    s_nop 1
    v_add_f32_dpp v65, v65, v65 row_ror:2 row_mask:0xf bank_mask:0xf
    s_nop 1
    v_add_f32_dpp v65, v65, v65 row_ror:1 row_mask:0xf bank_mask:0xf
    v_mov_b32 v48, v65
    s_nop 1
    v_permlane16_swap_b32 v65, v48
    v_add_f32 v65, v65, v48
    v_mov_b32 v48, v65
    s_nop 1
    v_permlane32_swap_b32 v65, v48
    v_add_f32 v65, v65, v48
    s_lshl_b32 s58, s3, 3
    v_mov_b32 v48, s58
    s_mov_b64 exec, 1
    ds_write_b64 v48, v[64:65] offset:4096
    s_mov_b64 exec, -1
    s_cmp_eq_u32 s50, 0
    s_cbranch_scc1 L_nolast
    s_mov_b32 s88, 200000
    v_lshlrev_b32 v60, 2, v1
L_cnt:
    global_load_dword v72, v60, s[84:85] sc1
    s_waitcnt vmcnt(0)
    v_cmp_eq_u32 vcc, 0, v72
    s_cbranch_vccz L_nolast
    s_sleep 8
    s_sub_u32 s88, s88, 1
    s_cbranch_scc0 L_cnt
L_nolast:
    s_waitcnt lgkmcnt(0)
    s_sub_u32 s58, s52, s48
    s_lshl_b32 s58, s58, 8
    s_sub_u32 s58, s58, s49
    s_add_u32 s49, s49, s57
    s_sub_u32 s101, s58, s100
    s_cmp_gt_i32 s101, 30720
    s_cselect_b32 s101, 56320, 0
    s_add_u32 s49, s49, s101
    s_sub_u32 s58, s58, s101
    s_mov_b32 s100, s58
    s_sub_u32 s19, s19, 1
    s_cmp_ge_i32 s19, 0
    s_cselect_b32 s58, 1, s58
    s_cmp_gt_i32 s58, 0
    s_cbranch_scc1 L_v_0_6
L_v_0_5:
    s_waitcnt vmcnt(4)
    s_cmp_gt_u32 s51, 5
    s_cbranch_scc1 L_v_0_5_s0
    buffer_load_dwordx4 v[148:151], v3, s[8:11], s54 offen offset:1024 nt
L_v_0_5_s0:
    v_mfma_f32_16x16x32_bf16 v[28:31], v[18:21], v[128:131], v[28:31]
    v_and_b32_dpp v22, v66, v14 row_newbcast:8 row_mask:0xf bank_mask:0xf
    v_and_b32_dpp v23, v66, v15 row_newbcast:8 row_mask:0xf bank_mask:0xf
    v_and_b32_dpp v24, v66, v16 row_newbcast:8 row_mask:0xf bank_mask:0xf
    v_and_b32_dpp v25, v66, v17 row_newbcast:8 row_mask:0xf bank_mask:0xf
    s_waitcnt vmcnt(4)
    buffer_load_dwordx4 v[152:155], v3, s[8:11], s54 offen offset:2048 nt
    s_mov_b32 s51, 5
    v_mfma_f32_16x16x32_bf16 v[28:31], v[22:25], v[132:135], v[28:31]
    v_and_b32_dpp v18, v66, v14 row_newbcast:4 row_mask:0xf bank_mask:0xf
    v_and_b32_dpp v19, v66, v15 row_newbcast:4 row_mask:0xf bank_mask:0xf
    v_and_b32_dpp v20, v66, v16 row_newbcast:4 row_mask:0xf bank_mask:0xf
    v_and_b32_dpp v21, v66, v17 row_newbcast:4 row_mask:0xf bank_mask:0xf
    s_waitcnt vmcnt(4)
    buffer_load_dwordx4 v[156:159], v3, s[8:11], s54 offen offset:3072 nt
    v_mfma_f32_16x16x32_bf16 v[28:31], v[18:21], v[136:139], v[28:31]
    v_and_b32_dpp v22, v66, v14 row_newbcast:12 row_mask:0xf bank_mask:0xf
    v_and_b32_dpp v23, v66, v15 row_newbcast:12 row_mask:0xf bank_mask:0xf
    v_and_b32_dpp v24, v66, v16 row_newbcast:12 row_mask:0xf bank_mask:0xf
    v_and_b32_dpp v25, v66, v17 row_newbcast:12 row_mask:0xf bank_mask:0xf
    s_waitcnt vmcnt(4)
    buffer_load_dwordx4 v[160:163], v4, s[8:11], s54 offen offset:0 nt
    v_mfma_f32_16x16x32_bf16 v[28:31], v[22:25], v[140:143], v[28:31]
    v_and_b32_dpp v18, v66, v14 row_newbcast:2 row_mask:0xf bank_mask:0xf
    v_and_b32_dpp v19, v66, v15 row_newbcast:2 row_mask:0xf bank_mask:0xf
    v_and_b32_dpp v20, v66, v16 row_newbcast:2 row_mask:0xf bank_mask:0xf
    v_and_b32_dpp v21, v66, v17 row_newbcast:2 row_mask:0xf bank_mask:0xf
    s_waitcnt vmcnt(4)
    buffer_load_dwordx4 v[164:167], v4, s[8:11], s54 offen offset:1024 nt
    v_mfma_f32_16x16x32_bf16 v[28:31], v[18:21], v[144:147], v[28:31]
    v_and_b32_dpp v22, v66, v14 row_newbcast:10 row_mask:0xf bank_mask:0xf
    v_and_b32_dpp v23, v66, v15 row_newbcast:10 row_mask:0xf bank_mask:0xf
    v_and_b32_dpp v24, v66, v16 row_newbcast:10 row_mask:0xf bank_mask:0xf
    v_and_b32_dpp v25, v66, v17 row_newbcast:10 row_mask:0xf bank_mask:0xf
    s_waitcnt vmcnt(4)
    buffer_load_dwordx4 v[168:171], v4, s[8:11], s54 offen offset:2048 nt
    v_mfma_f32_16x16x32_bf16 v[28:31], v[22:25], v[148:151], v[28:31]
    v_and_b32_dpp v18, v66, v14 row_newbcast:6 row_mask:0xf bank_mask:0xf
    v_and_b32_dpp v19, v66, v15 row_newbcast:6 row_mask:0xf bank_mask:0xf
    v_and_b32_dpp v20, v66, v16 row_newbcast:6 row_mask:0xf bank_mask:0xf
    v_and_b32_dpp v21, v66, v17 row_newbcast:6 row_mask:0xf bank_mask:0xf
    s_waitcnt vmcnt(4)
    buffer_load_dwordx4 v[172:175], v4, s[8:11], s54 offen offset:3072 nt
    v_mfma_f32_16x16x32_bf16 v[28:31], v[18:21], v[152:155], v[28:31]
    v_and_b32_dpp v22, v66, v14 row_newbcast:14 row_mask:0xf bank_mask:0xf
    v_and_b32_dpp v23, v66, v15 row_newbcast:14 row_mask:0xf bank_mask:0xf
    v_and_b32_dpp v24, v66, v16 row_newbcast:14 row_mask:0xf bank_mask:0xf
    v_and_b32_dpp v25, v66, v17 row_newbcast:14 row_mask:0xf bank_mask:0xf
    s_waitcnt vmcnt(4)
    buffer_load_dwordx4 v[176:179], v5, s[8:11], s54 offen offset:0 nt
    v_mfma_f32_16x16x32_bf16 v[28:31], v[22:25], v[156:159], v[28:31]
    v_and_b32_dpp v18, v66, v14 row_newbcast:1 row_mask:0xf bank_mask:0xf
    v_and_b32_dpp v19, v66, v15 row_newbcast:1 row_mask:0xf bank_mask:0xf
    v_and_b32_dpp v20, v66, v16 row_newbcast:1 row_mask:0xf bank_mask:0xf
    v_and_b32_dpp v21, v66, v17 row_newbcast:1 row_mask:0xf bank_mask:0xf
    s_waitcnt vmcnt(4)
    buffer_load_dwordx4 v[180:183], v5, s[8:11], s54 offen offset:1024 nt
    v_mfma_f32_16x16x32_bf16 v[28:31], v[18:21], v[160:163], v[28:31]
    v_and_b32_dpp v22, v66, v14 row_newbcast:9 row_mask:0xf bank_mask:0xf
    v_and_b32_dpp v23, v66, v15 row_newbcast:9 row_mask:0xf bank_mask:0xf
    v_and_b32_dpp v24, v66, v16 row_newbcast:9 row_mask:0xf bank_mask:0xf
    v_and_b32_dpp v25, v66, v17 row_newbcast:9 row_mask:0xf bank_mask:0xf
    s_waitcnt vmcnt(4)
    buffer_load_dwordx4 v[184:187], v5, s[8:11], s54 offen offset:2048 nt
    v_mfma_f32_16x16x32_bf16 v[28:31], v[22:25], v[164:167], v[28:31]
    v_and_b32_dpp v18, v66, v14 row_newbcast:5 row_mask:0xf bank_mask:0xf
    v_and_b32_dpp v19, v66, v15 row_newbcast:5 row_mask:0xf bank_mask:0xf
    v_and_b32_dpp v20, v66, v16 row_newbcast:5 row_mask:0xf bank_mask:0xf
    v_and_b32_dpp v21, v66, v17 row_newbcast:5 row_mask:0xf bank_mask:0xf
    s_waitcnt vmcnt(4)
    buffer_load_dwordx4 v[188:191], v5, s[8:11], s54 offen offset:3072 nt
    v_mfma_f32_16x16x32_bf16 v[28:31], v[18:21], v[168:171], v[28:31]
    v_and_b32_dpp v22, v66, v14 row_newbcast:13 row_mask:0xf bank_mask:0xf
    v_and_b32_dpp v23, v66, v15 row_newbcast:13 row_mask:0xf bank_mask:0xf
    v_and_b32_dpp v24, v66, v16 row_newbcast:13 row_mask:0xf bank_mask:0xf
    v_and_b32_dpp v25, v66, v17 row_newbcast:13 row_mask:0xf bank_mask:0xf
    s_waitcnt vmcnt(4)
    buffer_load_dwordx4 v[192:195], v6, s[8:11], s54 offen offset:0 nt
    v_mfma_f32_16x16x32_bf16 v[28:31], v[22:25], v[172:175], v[28:31]
    v_and_b32_dpp v18, v66, v14 row_newbcast:3 row_mask:0xf bank_mask:0xf
    v_and_b32_dpp v19, v66, v15 row_newbcast:3 row_mask:0xf bank_mask:0xf
    v_and_b32_dpp v20, v66, v16 row_newbcast:3 row_mask:0xf bank_mask:0xf
    v_and_b32_dpp v21, v66, v17 row_newbcast:3 row_mask:0xf bank_mask:0xf
    s_waitcnt vmcnt(4)
    buffer_load_dwordx4 v[196:199], v6, s[8:11], s54 offen offset:1024 nt
    v_mfma_f32_16x16x32_bf16 v[28:31], v[18:21], v[176:179], v[28:31]
    v_and_b32_dpp v22, v66, v14 row_newbcast:11 row_mask:0xf bank_mask:0xf
    v_and_b32_dpp v23, v66, v15 row_newbcast:11 row_mask:0xf bank_mask:0xf
    v_and_b32_dpp v24, v66, v16 row_newbcast:11 row_mask:0xf bank_mask:0xf
    v_and_b32_dpp v25, v66, v17 row_newbcast:11 row_mask:0xf bank_mask:0xf
    s_waitcnt vmcnt(4)
    buffer_load_dwordx4 v[200:203], v6, s[8:11], s54 offen offset:2048 nt
    v_mfma_f32_16x16x32_bf16 v[28:31], v[22:25], v[180:183], v[28:31]
    v_and_b32_dpp v18, v66, v14 row_newbcast:7 row_mask:0xf bank_mask:0xf
    v_and_b32_dpp v19, v66, v15 row_newbcast:7 row_mask:0xf bank_mask:0xf
    v_and_b32_dpp v20, v66, v16 row_newbcast:7 row_mask:0xf bank_mask:0xf
    v_and_b32_dpp v21, v66, v17 row_newbcast:7 row_mask:0xf bank_mask:0xf
    s_waitcnt vmcnt(4)
    buffer_load_dwordx4 v[204:207], v6, s[8:11], s54 offen offset:3072 nt
    v_mfma_f32_16x16x32_bf16 v[28:31], v[18:21], v[184:187], v[28:31]
    v_and_b32_dpp v22, v66, v14 row_newbcast:15 row_mask:0xf bank_mask:0xf
    v_and_b32_dpp v23, v66, v15 row_newbcast:15 row_mask:0xf bank_mask:0xf
    v_and_b32_dpp v24, v66, v16 row_newbcast:15 row_mask:0xf bank_mask:0xf
    v_and_b32_dpp v25, v66, v17 row_newbcast:15 row_mask:0xf bank_mask:0xf
    s_waitcnt vmcnt(4)
    buffer_load_dwordx4 v[208:211], v7, s[8:11], s54 offen offset:0 nt
    s_memrealtime s[52:53]
    v_mfma_f32_16x16x32_bf16 v[28:31], v[22:25], v[188:191], v[28:31]
    v_and_b32_dpp v18, v67, v14 row_newbcast:0 row_mask:0xf bank_mask:0xf
    v_and_b32_dpp v19, v67, v15 row_newbcast:0 row_mask:0xf bank_mask:0xf
    v_and_b32_dpp v20, v67, v16 row_newbcast:0 row_mask:0xf bank_mask:0xf
    v_and_b32_dpp v21, v67, v17 row_newbcast:0 row_mask:0xf bank_mask:0xf
L_v_mid:
    s_cmp_eq_u32 s56, 7
    s_cbranch_scc1 L_v_f
    s_waitcnt lgkmcnt(0)
    s_sub_u32 s58, s52, s48
    s_lshl_b32 s58, s58, 8
    s_sub_u32 s58, s58, s49
    s_add_u32 s49, s49, s57
    s_sub_u32 s101, s58, s100
    s_cmp_gt_i32 s101, 30720
    s_cselect_b32 s101, 56320, 0
    s_add_u32 s49, s49, s101
    s_sub_u32 s58, s58, s101
    s_mov_b32 s100, s58
    s_sub_u32 s19, s19, 1
    s_cmp_ge_i32 s19, 0
    s_cselect_b32 s58, 1, s58
    s_cmp_gt_i32 s58, 0
    s_cbranch_scc1 L_v_1_6
L_v_1_5:
    s_waitcnt vmcnt(4)
    s_cmp_gt_u32 s51, 5
    s_cbranch_scc1 L_v_1_5_s16
    buffer_load_dwordx4 v[212:215], v7, s[8:11], s54 offen offset:1024 nt
L_v_1_5_s16:
    v_mfma_f32_16x16x32_bf16 v[28:31], v[18:21], v[192:195], v[28:31]
    v_and_b32_dpp v22, v67, v14 row_newbcast:8 row_mask:0xf bank_mask:0xf
    v_and_b32_dpp v23, v67, v15 row_newbcast:8 row_mask:0xf bank_mask:0xf
    v_and_b32_dpp v24, v67, v16 row_newbcast:8 row_mask:0xf bank_mask:0xf
    v_and_b32_dpp v25, v67, v17 row_newbcast:8 row_mask:0xf bank_mask:0xf
    s_waitcnt vmcnt(4)
    buffer_load_dwordx4 v[216:219], v7, s[8:11], s54 offen offset:2048 nt
    s_mov_b32 s51, 5
    v_mfma_f32_16x16x32_bf16 v[28:31], v[22:25], v[196:199], v[28:31]
    v_and_b32_dpp v18, v67, v14 row_newbcast:4 row_mask:0xf bank_mask:0xf
    v_and_b32_dpp v19, v67, v15 row_newbcast:4 row_mask:0xf bank_mask:0xf
    v_and_b32_dpp v20, v67, v16 row_newbcast:4 row_mask:0xf bank_mask:0xf
    v_and_b32_dpp v21, v67, v17 row_newbcast:4 row_mask:0xf bank_mask:0xf
    s_waitcnt vmcnt(4)
    buffer_load_dwordx4 v[220:223], v7, s[8:11], s54 offen offset:3072 nt
    v_mfma_f32_16x16x32_bf16 v[28:31], v[18:21], v[200:203], v[28:31]
    v_and_b32_dpp v22, v67, v14 row_newbcast:12 row_mask:0xf bank_mask:0xf
    v_and_b32_dpp v23, v67, v15 row_newbcast:12 row_mask:0xf bank_mask:0xf
    v_and_b32_dpp v24, v67, v16 row_newbcast:12 row_mask:0xf bank_mask:0xf
    v_and_b32_dpp v25, v67, v17 row_newbcast:12 row_mask:0xf bank_mask:0xf
    s_waitcnt vmcnt(4)
    buffer_load_dwordx4 v[224:227], v8, s[8:11], s54 offen offset:0 nt
    v_mfma_f32_16x16x32_bf16 v[28:31], v[22:25], v[204:207], v[28:31]
    v_and_b32_dpp v18, v67, v14 row_newbcast:2 row_mask:0xf bank_mask:0xf
    v_and_b32_dpp v19, v67, v15 row_newbcast:2 row_mask:0xf bank_mask:0xf
    v_and_b32_dpp v20, v67, v16 row_newbcast:2 row_mask:0xf bank_mask:0xf
    v_and_b32_dpp v21, v67, v17 row_newbcast:2 row_mask:0xf bank_mask:0xf
    s_waitcnt vmcnt(4)
    buffer_load_dwordx4 v[228:231], v8, s[8:11], s54 offen offset:1024 nt
    v_mfma_f32_16x16x32_bf16 v[28:31], v[18:21], v[208:211], v[28:31]
    v_and_b32_dpp v22, v67, v14 row_newbcast:10 row_mask:0xf bank_mask:0xf
    v_and_b32_dpp v23, v67, v15 row_newbcast:10 row_mask:0xf bank_mask:0xf
    v_and_b32_dpp v24, v67, v16 row_newbcast:10 row_mask:0xf bank_mask:0xf
    v_and_b32_dpp v25, v67, v17 row_newbcast:10 row_mask:0xf bank_mask:0xf
    s_waitcnt vmcnt(4)
    buffer_load_dwordx4 v[232:235], v8, s[8:11], s54 offen offset:2048 nt
    v_mfma_f32_16x16x32_bf16 v[28:31], v[22:25], v[212:215], v[28:31]
    v_and_b32_dpp v18, v67, v14 row_newbcast:6 row_mask:0xf bank_mask:0xf
    v_and_b32_dpp v19, v67, v15 row_newbcast:6 row_mask:0xf bank_mask:0xf
    v_and_b32_dpp v20, v67, v16 row_newbcast:6 row_mask:0xf bank_mask:0xf
    v_and_b32_dpp v21, v67, v17 row_newbcast:6 row_mask:0xf bank_mask:0xf
    s_waitcnt vmcnt(4)
    buffer_load_dwordx4 v[236:239], v8, s[8:11], s54 offen offset:3072 nt
    v_mfma_f32_16x16x32_bf16 v[28:31], v[18:21], v[216:219], v[28:31]
    v_and_b32_dpp v22, v67, v14 row_newbcast:14 row_mask:0xf bank_mask:0xf
    v_and_b32_dpp v23, v67, v15 row_newbcast:14 row_mask:0xf bank_mask:0xf
    v_and_b32_dpp v24, v67, v16 row_newbcast:14 row_mask:0xf bank_mask:0xf
    v_and_b32_dpp v25, v67, v17 row_newbcast:14 row_mask:0xf bank_mask:0xf
    s_waitcnt vmcnt(4)
    buffer_load_dwordx4 v[240:243], v9, s[8:11], s54 offen offset:0 nt
    v_mfma_f32_16x16x32_bf16 v[28:31], v[22:25], v[220:223], v[28:31]
    v_and_b32_dpp v18, v67, v14 row_newbcast:1 row_mask:0xf bank_mask:0xf
    v_and_b32_dpp v19, v67, v15 row_newbcast:1 row_mask:0xf bank_mask:0xf
    v_and_b32_dpp v20, v67, v16 row_newbcast:1 row_mask:0xf bank_mask:0xf
    v_and_b32_dpp v21, v67, v17 row_newbcast:1 row_mask:0xf bank_mask:0xf
    s_waitcnt vmcnt(4)
    buffer_load_dwordx4 v[244:247], v9, s[8:11], s54 offen offset:1024 nt
    v_mfma_f32_16x16x32_bf16 v[28:31], v[18:21], v[224:227], v[28:31]
    v_and_b32_dpp v22, v67, v14 row_newbcast:9 row_mask:0xf bank_mask:0xf
    v_and_b32_dpp v23, v67, v15 row_newbcast:9 row_mask:0xf bank_mask:0xf
    v_and_b32_dpp v24, v67, v16 row_newbcast:9 row_mask:0xf bank_mask:0xf
    v_and_b32_dpp v25, v67, v17 row_newbcast:9 row_mask:0xf bank_mask:0xf
    s_waitcnt vmcnt(4)
    buffer_load_dwordx4 v[248:251], v9, s[8:11], s54 offen offset:2048 nt
    v_mfma_f32_16x16x32_bf16 v[28:31], v[22:25], v[228:231], v[28:31]
    v_and_b32_dpp v18, v67, v14 row_newbcast:5 row_mask:0xf bank_mask:0xf
    v_and_b32_dpp v19, v67, v15 row_newbcast:5 row_mask:0xf bank_mask:0xf
    v_and_b32_dpp v20, v67, v16 row_newbcast:5 row_mask:0xf bank_mask:0xf
    v_and_b32_dpp v21, v67, v17 row_newbcast:5 row_mask:0xf bank_mask:0xf
    s_waitcnt vmcnt(4)
    buffer_load_dwordx4 v[252:255], v9, s[8:11], s54 offen offset:3072 nt
    v_mfma_f32_16x16x32_bf16 v[28:31], v[18:21], v[232:235], v[28:31]
    v_and_b32_dpp v22, v67, v14 row_newbcast:13 row_mask:0xf bank_mask:0xf
    v_and_b32_dpp v23, v67, v15 row_newbcast:13 row_mask:0xf bank_mask:0xf
    v_and_b32_dpp v24, v67, v16 row_newbcast:13 row_mask:0xf bank_mask:0xf
    v_and_b32_dpp v25, v67, v17 row_newbcast:13 row_mask:0xf bank_mask:0xf
    s_waitcnt vmcnt(4)
    buffer_load_dwordx4 v[128:131], v2, s[12:15], s55 offen offset:0 nt
    v_mfma_f32_16x16x32_bf16 v[28:31], v[22:25], v[236:239], v[28:31]
    v_and_b32_dpp v18, v67, v14 row_newbcast:3 row_mask:0xf bank_mask:0xf
    v_and_b32_dpp v19, v67, v15 row_newbcast:3 row_mask:0xf bank_mask:0xf
    v_and_b32_dpp v20, v67, v16 row_newbcast:3 row_mask:0xf bank_mask:0xf
    v_and_b32_dpp v21, v67, v17 row_newbcast:3 row_mask:0xf bank_mask:0xf
    s_waitcnt vmcnt(4)
    buffer_load_dwordx4 v[132:135], v2, s[12:15], s55 offen offset:1024 nt
    v_mfma_f32_16x16x32_bf16 v[28:31], v[18:21], v[240:243], v[28:31]
    v_and_b32_dpp v22, v67, v14 row_newbcast:11 row_mask:0xf bank_mask:0xf
    v_and_b32_dpp v23, v67, v15 row_newbcast:11 row_mask:0xf bank_mask:0xf
    v_and_b32_dpp v24, v67, v16 row_newbcast:11 row_mask:0xf bank_mask:0xf
    v_and_b32_dpp v25, v67, v17 row_newbcast:11 row_mask:0xf bank_mask:0xf
    s_waitcnt vmcnt(4)
    buffer_load_dwordx4 v[136:139], v2, s[12:15], s55 offen offset:2048 nt
    v_mfma_f32_16x16x32_bf16 v[28:31], v[22:25], v[244:247], v[28:31]
    v_and_b32_dpp v18, v67, v14 row_newbcast:7 row_mask:0xf bank_mask:0xf
    v_and_b32_dpp v19, v67, v15 row_newbcast:7 row_mask:0xf bank_mask:0xf
    v_and_b32_dpp v20, v67, v16 row_newbcast:7 row_mask:0xf bank_mask:0xf
    v_and_b32_dpp v21, v67, v17 row_newbcast:7 row_mask:0xf bank_mask:0xf
    s_waitcnt vmcnt(4)
    buffer_load_dwordx4 v[140:143], v2, s[12:15], s55 offen offset:3072 nt
    v_mfma_f32_16x16x32_bf16 v[28:31], v[18:21], v[248:251], v[28:31]
    v_and_b32_dpp v22, v67, v14 row_newbcast:15 row_mask:0xf bank_mask:0xf
    v_and_b32_dpp v23, v67, v15 row_newbcast:15 row_mask:0xf bank_mask:0xf
    v_and_b32_dpp v24, v67, v16 row_newbcast:15 row_mask:0xf bank_mask:0xf
    v_and_b32_dpp v25, v67, v17 row_newbcast:15 row_mask:0xf bank_mask:0xf
    s_waitcnt vmcnt(4)
    buffer_load_dwordx4 v[144:147], v3, s[12:15], s55 offen offset:0 nt
    s_memrealtime s[52:53]
    v_mfma_f32_16x16x32_bf16 v[28:31], v[22:25], v[252:255], v[28:31]
L_v_nxt:
    s_add_u32 s56, s56, 1
    s_cmp_lt_u32 s56, 8
    s_cbranch_scc1 L_v
    s_branch L_v_end
L_v_0_6:
    s_cmp_gt_u32 s51, 5
    s_cbranch_scc1 L_v_0_6_i5
    buffer_load_dwordx4 v[148:151], v3, s[8:11], s54 offen offset:1024 nt
L_v_0_6_i5:
    s_waitcnt vmcnt(5)
    buffer_load_dwordx4 v[152:155], v3, s[8:11], s54 offen offset:2048 nt
    s_mov_b32 s51, 6
    v_mfma_f32_16x16x32_bf16 v[28:31], v[18:21], v[128:131], v[28:31]
    v_and_b32_dpp v22, v66, v14 row_newbcast:8 row_mask:0xf bank_mask:0xf
    v_and_b32_dpp v23, v66, v15 row_newbcast:8 row_mask:0xf bank_mask:0xf
    v_and_b32_dpp v24, v66, v16 row_newbcast:8 row_mask:0xf bank_mask:0xf
    v_and_b32_dpp v25, v66, v17 row_newbcast:8 row_mask:0xf bank_mask:0xf
    s_waitcnt vmcnt(5)
    buffer_load_dwordx4 v[156:159], v3, s[8:11], s54 offen offset:3072 nt
    v_mfma_f32_16x16x32_bf16 v[28:31], v[22:25], v[132:135], v[28:31]
    v_and_b32_dpp v18, v66, v14 row_newbcast:4 row_mask:0xf bank_mask:0xf
    v_and_b32_dpp v19, v66, v15 row_newbcast:4 row_mask:0xf bank_mask:0xf
    v_and_b32_dpp v20, v66, v16 row_newbcast:4 row_mask:0xf bank_mask:0xf
    v_and_b32_dpp v21, v66, v17 row_newbcast:4 row_mask:0xf bank_mask:0xf
    s_waitcnt vmcnt(5)
    buffer_load_dwordx4 v[160:163], v4, s[8:11], s54 offen offset:0 nt
    v_mfma_f32_16x16x32_bf16 v[28:31], v[18:21], v[136:139], v[28:31]
    v_and_b32_dpp v22, v66, v14 row_newbcast:12 row_mask:0xf bank_mask:0xf
    v_and_b32_dpp v23, v66, v15 row_newbcast:12 row_mask:0xf bank_mask:0xf
    v_and_b32_dpp v24, v66, v16 row_newbcast:12 row_mask:0xf bank_mask:0xf
    v_and_b32_dpp v25, v66, v17 row_newbcast:12 row_mask:0xf bank_mask:0xf
    s_waitcnt vmcnt(5)
    buffer_load_dwordx4 v[164:167], v4, s[8:11], s54 offen offset:1024 nt
    v_mfma_f32_16x16x32_bf16 v[28:31], v[22:25], v[140:143], v[28:31]
    v_and_b32_dpp v18, v66, v14 row_newbcast:2 row_mask:0xf bank_mask:0xf
    v_and_b32_dpp v19, v66, v15 row_newbcast:2 row_mask:0xf bank_mask:0xf
    v_and_b32_dpp v20, v66, v16 row_newbcast:2 row_mask:0xf bank_mask:0xf
    v_and_b32_dpp v21, v66, v17 row_newbcast:2 row_mask:0xf bank_mask:0xf
    s_waitcnt vmcnt(5)
    buffer_load_dwordx4 v[168:171], v4, s[8:11], s54 offen offset:2048 nt
    v_mfma_f32_16x16x32_bf16 v[28:31], v[18:21], v[144:147], v[28:31]
    v_and_b32_dpp v22, v66, v14 row_newbcast:10 row_mask:0xf bank_mask:0xf
    v_and_b32_dpp v23, v66, v15 row_newbcast:10 row_mask:0xf bank_mask:0xf
    v_and_b32_dpp v24, v66, v16 row_newbcast:10 row_mask:0xf bank_mask:0xf
    v_and_b32_dpp v25, v66, v17 row_newbcast:10 row_mask:0xf bank_mask:0xf
    s_waitcnt vmcnt(5)
    buffer_load_dwordx4 v[172:175], v4, s[8:11], s54 offen offset:3072 nt
    v_mfma_f32_16x16x32_bf16 v[28:31], v[22:25], v[148:151], v[28:31]
    v_and_b32_dpp v18, v66, v14 row_newbcast:6 row_mask:0xf bank_mask:0xf
    v_and_b32_dpp v19, v66, v15 row_newbcast:6 row_mask:0xf bank_mask:0xf
    v_and_b32_dpp v20, v66, v16 row_newbcast:6 row_mask:0xf bank_mask:0xf
    v_and_b32_dpp v21, v66, v17 row_newbcast:6 row_mask:0xf bank_mask:0xf
    s_waitcnt vmcnt(5)
    buffer_load_dwordx4 v[176:179], v5, s[8:11], s54 offen offset:0 nt
    v_mfma_f32_16x16x32_bf16 v[28:31], v[18:21], v[152:155], v[28:31]
    v_and_b32_dpp v22, v66, v14 row_newbcast:14 row_mask:0xf bank_mask:0xf
    v_and_b32_dpp v23, v66, v15 row_newbcast:14 row_mask:0xf bank_mask:0xf
    v_and_b32_dpp v24, v66, v16 row_newbcast:14 row_mask:0xf bank_mask:0xf
    v_and_b32_dpp v25, v66, v17 row_newbcast:14 row_mask:0xf bank_mask:0xf
    s_waitcnt vmcnt(5)
    buffer_load_dwordx4 v[180:183], v5, s[8:11], s54 offen offset:1024 nt
    v_mfma_f32_16x16x32_bf16 v[28:31], v[22:25], v[156:159], v[28:31]
    v_and_b32_dpp v18, v66, v14 row_newbcast:1 row_mask:0xf bank_mask:0xf
    v_and_b32_dpp v19, v66, v15 row_newbcast:1 row_mask:0xf bank_mask:0xf
    v_and_b32_dpp v20, v66, v16 row_newbcast:1 row_mask:0xf bank_mask:0xf
    v_and_b32_dpp v21, v66, v17 row_newbcast:1 row_mask:0xf bank_mask:0xf
    s_waitcnt vmcnt(5)
    buffer_load_dwordx4 v[184:187], v5, s[8:11], s54 offen offset:2048 nt
    v_mfma_f32_16x16x32_bf16 v[28:31], v[18:21], v[160:163], v[28:31]
    v_and_b32_dpp v22, v66, v14 row_newbcast:9 row_mask:0xf bank_mask:0xf
    v_and_b32_dpp v23, v66, v15 row_newbcast:9 row_mask:0xf bank_mask:0xf
    v_and_b32_dpp v24, v66, v16 row_newbcast:9 row_mask:0xf bank_mask:0xf
    v_and_b32_dpp v25, v66, v17 row_newbcast:9 row_mask:0xf bank_mask:0xf
    s_waitcnt vmcnt(5)
    buffer_load_dwordx4 v[188:191], v5, s[8:11], s54 offen offset:3072 nt
    v_mfma_f32_16x16x32_bf16 v[28:31], v[22:25], v[164:167], v[28:31]
    v_and_b32_dpp v18, v66, v14 row_newbcast:5 row_mask:0xf bank_mask:0xf
    v_and_b32_dpp v19, v66, v15 row_newbcast:5 row_mask:0xf bank_mask:0xf
    v_and_b32_dpp v20, v66, v16 row_newbcast:5 row_mask:0xf bank_mask:0xf
    v_and_b32_dpp v21, v66, v17 row_newbcast:5 row_mask:0xf bank_mask:0xf
    s_waitcnt vmcnt(5)
    buffer_load_dwordx4 v[192:195], v6, s[8:11], s54 offen offset:0 nt
    v_mfma_f32_16x16x32_bf16 v[28:31], v[18:21], v[168:171], v[28:31]
    v_and_b32_dpp v22, v66, v14 row_newbcast:13 row_mask:0xf bank_mask:0xf
    v_and_b32_dpp v23, v66, v15 row_newbcast:13 row_mask:0xf bank_mask:0xf
    v_and_b32_dpp v24, v66, v16 row_newbcast:13 row_mask:0xf bank_mask:0xf
    v_and_b32_dpp v25, v66, v17 row_newbcast:13 row_mask:0xf bank_mask:0xf
    s_waitcnt vmcnt(5)
    buffer_load_dwordx4 v[196:199], v6, s[8:11], s54 offen offset:1024 nt
    v_mfma_f32_16x16x32_bf16 v[28:31], v[22:25], v[172:175], v[28:31]
    v_and_b32_dpp v18, v66, v14 row_newbcast:3 row_mask:0xf bank_mask:0xf
    v_and_b32_dpp v19, v66, v15 row_newbcast:3 row_mask:0xf bank_mask:0xf
    v_and_b32_dpp v20, v66, v16 row_newbcast:3 row_mask:0xf bank_mask:0xf
    v_and_b32_dpp v21, v66, v17 row_newbcast:3 row_mask:0xf bank_mask:0xf
    s_waitcnt vmcnt(5)
    buffer_load_dwordx4 v[200:203], v6, s[8:11], s54 offen offset:2048 nt
    v_mfma_f32_16x16x32_bf16 v[28:31], v[18:21], v[176:179], v[28:31]
    v_and_b32_dpp v22, v66, v14 row_newbcast:11 row_mask:0xf bank_mask:0xf
    v_and_b32_dpp v23, v66, v15 row_newbcast:11 row_mask:0xf bank_mask:0xf
    v_and_b32_dpp v24, v66, v16 row_newbcast:11 row_mask:0xf bank_mask:0xf
    v_and_b32_dpp v25, v66, v17 row_newbcast:11 row_mask:0xf bank_mask:0xf
    s_waitcnt vmcnt(5)
    buffer_load_dwordx4 v[204:207], v6, s[8:11], s54 offen offset:3072 nt
    v_mfma_f32_16x16x32_bf16 v[28:31], v[22:25], v[180:183], v[28:31]
    v_and_b32_dpp v18, v66, v14 row_newbcast:7 row_mask:0xf bank_mask:0xf
    v_and_b32_dpp v19, v66, v15 row_newbcast:7 row_mask:0xf bank_mask:0xf
    v_and_b32_dpp v20, v66, v16 row_newbcast:7 row_mask:0xf bank_mask:0xf
    v_and_b32_dpp v21, v66, v17 row_newbcast:7 row_mask:0xf bank_mask:0xf
    s_waitcnt vmcnt(5)
    buffer_load_dwordx4 v[208:211], v7, s[8:11], s54 offen offset:0 nt
    v_mfma_f32_16x16x32_bf16 v[28:31], v[18:21], v[184:187], v[28:31]
    v_and_b32_dpp v22, v66, v14 row_newbcast:15 row_mask:0xf bank_mask:0xf
    v_and_b32_dpp v23, v66, v15 row_newbcast:15 row_mask:0xf bank_mask:0xf
    v_and_b32_dpp v24, v66, v16 row_newbcast:15 row_mask:0xf bank_mask:0xf
    v_and_b32_dpp v25, v66, v17 row_newbcast:15 row_mask:0xf bank_mask:0xf
    s_waitcnt vmcnt(5)
    buffer_load_dwordx4 v[212:215], v7, s[8:11], s54 offen offset:1024 nt
    s_memrealtime s[52:53]
    v_mfma_f32_16x16x32_bf16 v[28:31], v[22:25], v[188:191], v[28:31]
    v_and_b32_dpp v18, v67, v14 row_newbcast:0 row_mask:0xf bank_mask:0xf
    v_and_b32_dpp v19, v67, v15 row_newbcast:0 row_mask:0xf bank_mask:0xf
    v_and_b32_dpp v20, v67, v16 row_newbcast:0 row_mask:0xf bank_mask:0xf
    v_and_b32_dpp v21, v67, v17 row_newbcast:0 row_mask:0xf bank_mask:0xf
    s_branch L_v_mid
L_v_1_6:
    s_cmp_gt_u32 s51, 5
    s_cbranch_scc1 L_v_1_6_i5
    buffer_load_dwordx4 v[212:215], v7, s[8:11], s54 offen offset:1024 nt
L_v_1_6_i5:
    s_waitcnt vmcnt(5)
    buffer_load_dwordx4 v[216:219], v7, s[8:11], s54 offen offset:2048 nt
    s_mov_b32 s51, 6
    v_mfma_f32_16x16x32_bf16 v[28:31], v[18:21], v[192:195], v[28:31]
    v_and_b32_dpp v22, v67, v14 row_newbcast:8 row_mask:0xf bank_mask:0xf
    v_and_b32_dpp v23, v67, v15 row_newbcast:8 row_mask:0xf bank_mask:0xf
    v_and_b32_dpp v24, v67, v16 row_newbcast:8 row_mask:0xf bank_mask:0xf
    v_and_b32_dpp v25, v67, v17 row_newbcast:8 row_mask:0xf bank_mask:0xf
    s_waitcnt vmcnt(5)
    buffer_load_dwordx4 v[220:223], v7, s[8:11], s54 offen offset:3072 nt
    v_mfma_f32_16x16x32_bf16 v[28:31], v[22:25], v[196:199], v[28:31]
    v_and_b32_dpp v18, v67, v14 row_newbcast:4 row_mask:0xf bank_mask:0xf
    v_and_b32_dpp v19, v67, v15 row_newbcast:4 row_mask:0xf bank_mask:0xf
    v_and_b32_dpp v20, v67, v16 row_newbcast:4 row_mask:0xf bank_mask:0xf
    v_and_b32_dpp v21, v67, v17 row_newbcast:4 row_mask:0xf bank_mask:0xf
    s_waitcnt vmcnt(5)
    buffer_load_dwordx4 v[224:227], v8, s[8:11], s54 offen offset:0 nt
    v_mfma_f32_16x16x32_bf16 v[28:31], v[18:21], v[200:203], v[28:31]
    v_and_b32_dpp v22, v67, v14 row_newbcast:12 row_mask:0xf bank_mask:0xf
    v_and_b32_dpp v23, v67, v15 row_newbcast:12 row_mask:0xf bank_mask:0xf
    v_and_b32_dpp v24, v67, v16 row_newbcast:12 row_mask:0xf bank_mask:0xf
    v_and_b32_dpp v25, v67, v17 row_newbcast:12 row_mask:0xf bank_mask:0xf
    s_waitcnt vmcnt(5)
    buffer_load_dwordx4 v[228:231], v8, s[8:11], s54 offen offset:1024 nt
    v_mfma_f32_16x16x32_bf16 v[28:31], v[22:25], v[204:207], v[28:31]
    v_and_b32_dpp v18, v67, v14 row_newbcast:2 row_mask:0xf bank_mask:0xf
    v_and_b32_dpp v19, v67, v15 row_newbcast:2 row_mask:0xf bank_mask:0xf
    v_and_b32_dpp v20, v67, v16 row_newbcast:2 row_mask:0xf bank_mask:0xf
    v_and_b32_dpp v21, v67, v17 row_newbcast:2 row_mask:0xf bank_mask:0xf
    s_waitcnt vmcnt(5)
    buffer_load_dwordx4 v[232:235], v8, s[8:11], s54 offen offset:2048 nt
    v_mfma_f32_16x16x32_bf16 v[28:31], v[18:21], v[208:211], v[28:31]
    v_and_b32_dpp v22, v67, v14 row_newbcast:10 row_mask:0xf bank_mask:0xf
    v_and_b32_dpp v23, v67, v15 row_newbcast:10 row_mask:0xf bank_mask:0xf
    v_and_b32_dpp v24, v67, v16 row_newbcast:10 row_mask:0xf bank_mask:0xf
    v_and_b32_dpp v25, v67, v17 row_newbcast:10 row_mask:0xf bank_mask:0xf
    s_waitcnt vmcnt(5)
    buffer_load_dwordx4 v[236:239], v8, s[8:11], s54 offen offset:3072 nt
    v_mfma_f32_16x16x32_bf16 v[28:31], v[22:25], v[212:215], v[28:31]
    v_and_b32_dpp v18, v67, v14 row_newbcast:6 row_mask:0xf bank_mask:0xf
    v_and_b32_dpp v19, v67, v15 row_newbcast:6 row_mask:0xf bank_mask:0xf
    v_and_b32_dpp v20, v67, v16 row_newbcast:6 row_mask:0xf bank_mask:0xf
    v_and_b32_dpp v21, v67, v17 row_newbcast:6 row_mask:0xf bank_mask:0xf
    s_waitcnt vmcnt(5)
    buffer_load_dwordx4 v[240:243], v9, s[8:11], s54 offen offset:0 nt
    v_mfma_f32_16x16x32_bf16 v[28:31], v[18:21], v[216:219], v[28:31]
    v_and_b32_dpp v22, v67, v14 row_newbcast:14 row_mask:0xf bank_mask:0xf
    v_and_b32_dpp v23, v67, v15 row_newbcast:14 row_mask:0xf bank_mask:0xf
    v_and_b32_dpp v24, v67, v16 row_newbcast:14 row_mask:0xf bank_mask:0xf
    v_and_b32_dpp v25, v67, v17 row_newbcast:14 row_mask:0xf bank_mask:0xf
    s_waitcnt vmcnt(5)
    buffer_load_dwordx4 v[244:247], v9, s[8:11], s54 offen offset:1024 nt
    v_mfma_f32_16x16x32_bf16 v[28:31], v[22:25], v[220:223], v[28:31]
    v_and_b32_dpp v18, v67, v14 row_newbcast:1 row_mask:0xf bank_mask:0xf
    v_and_b32_dpp v19, v67, v15 row_newbcast:1 row_mask:0xf bank_mask:0xf
    v_and_b32_dpp v20, v67, v16 row_newbcast:1 row_mask:0xf bank_mask:0xf
    v_and_b32_dpp v21, v67, v17 row_newbcast:1 row_mask:0xf bank_mask:0xf
    s_waitcnt vmcnt(5)
    buffer_load_dwordx4 v[248:251], v9, s[8:11], s54 offen offset:2048 nt
    v_mfma_f32_16x16x32_bf16 v[28:31], v[18:21], v[224:227], v[28:31]
    v_and_b32_dpp v22, v67, v14 row_newbcast:9 row_mask:0xf bank_mask:0xf
    v_and_b32_dpp v23, v67, v15 row_newbcast:9 row_mask:0xf bank_mask:0xf
    v_and_b32_dpp v24, v67, v16 row_newbcast:9 row_mask:0xf bank_mask:0xf
    v_and_b32_dpp v25, v67, v17 row_newbcast:9 row_mask:0xf bank_mask:0xf
    s_waitcnt vmcnt(5)
    buffer_load_dwordx4 v[252:255], v9, s[8:11], s54 offen offset:3072 nt
    v_mfma_f32_16x16x32_bf16 v[28:31], v[22:25], v[228:231], v[28:31]
    v_and_b32_dpp v18, v67, v14 row_newbcast:5 row_mask:0xf bank_mask:0xf
    v_and_b32_dpp v19, v67, v15 row_newbcast:5 row_mask:0xf bank_mask:0xf
    v_and_b32_dpp v20, v67, v16 row_newbcast:5 row_mask:0xf bank_mask:0xf
    v_and_b32_dpp v21, v67, v17 row_newbcast:5 row_mask:0xf bank_mask:0xf
    s_waitcnt vmcnt(5)
    buffer_load_dwordx4 v[128:131], v2, s[12:15], s55 offen offset:0 nt
    v_mfma_f32_16x16x32_bf16 v[28:31], v[18:21], v[232:235], v[28:31]
    v_and_b32_dpp v22, v67, v14 row_newbcast:13 row_mask:0xf bank_mask:0xf
    v_and_b32_dpp v23, v67, v15 row_newbcast:13 row_mask:0xf bank_mask:0xf
    v_and_b32_dpp v24, v67, v16 row_newbcast:13 row_mask:0xf bank_mask:0xf
    v_and_b32_dpp v25, v67, v17 row_newbcast:13 row_mask:0xf bank_mask:0xf
    s_waitcnt vmcnt(5)
    buffer_load_dwordx4 v[132:135], v2, s[12:15], s55 offen offset:1024 nt
    v_mfma_f32_16x16x32_bf16 v[28:31], v[22:25], v[236:239], v[28:31]
    v_and_b32_dpp v18, v67, v14 row_newbcast:3 row_mask:0xf bank_mask:0xf
    v_and_b32_dpp v19, v67, v15 row_newbcast:3 row_mask:0xf bank_mask:0xf
    v_and_b32_dpp v20, v67, v16 row_newbcast:3 row_mask:0xf bank_mask:0xf
    v_and_b32_dpp v21, v67, v17 row_newbcast:3 row_mask:0xf bank_mask:0xf
    s_waitcnt vmcnt(5)
    buffer_load_dwordx4 v[136:139], v2, s[12:15], s55 offen offset:2048 nt
    v_mfma_f32_16x16x32_bf16 v[28:31], v[18:21], v[240:243], v[28:31]
    v_and_b32_dpp v22, v67, v14 row_newbcast:11 row_mask:0xf bank_mask:0xf
    v_and_b32_dpp v23, v67, v15 row_newbcast:11 row_mask:0xf bank_mask:0xf
    v_and_b32_dpp v24, v67, v16 row_newbcast:11 row_mask:0xf bank_mask:0xf
    v_and_b32_dpp v25, v67, v17 row_newbcast:11 row_mask:0xf bank_mask:0xf
    s_waitcnt vmcnt(5)
    buffer_load_dwordx4 v[140:143], v2, s[12:15], s55 offen offset:3072 nt
    v_mfma_f32_16x16x32_bf16 v[28:31], v[22:25], v[244:247], v[28:31]
    v_and_b32_dpp v18, v67, v14 row_newbcast:7 row_mask:0xf bank_mask:0xf
    v_and_b32_dpp v19, v67, v15 row_newbcast:7 row_mask:0xf bank_mask:0xf
    v_and_b32_dpp v20, v67, v16 row_newbcast:7 row_mask:0xf bank_mask:0xf
    v_and_b32_dpp v21, v67, v17 row_newbcast:7 row_mask:0xf bank_mask:0xf
    s_waitcnt vmcnt(5)
    buffer_load_dwordx4 v[144:147], v3, s[12:15], s55 offen offset:0 nt
    v_mfma_f32_16x16x32_bf16 v[28:31], v[18:21], v[248:251], v[28:31]
    v_and_b32_dpp v22, v67, v14 row_newbcast:15 row_mask:0xf bank_mask:0xf
    v_and_b32_dpp v23, v67, v15 row_newbcast:15 row_mask:0xf bank_mask:0xf
    v_and_b32_dpp v24, v67, v16 row_newbcast:15 row_mask:0xf bank_mask:0xf
    v_and_b32_dpp v25, v67, v17 row_newbcast:15 row_mask:0xf bank_mask:0xf
    s_waitcnt vmcnt(5)
    buffer_load_dwordx4 v[148:151], v3, s[12:15], s55 offen offset:1024 nt
    s_memrealtime s[52:53]
    v_mfma_f32_16x16x32_bf16 v[28:31], v[22:25], v[252:255], v[28:31]
    s_branch L_v_nxt
L_v_f:
    s_cmp_gt_u32 s51, 5
    s_cbranch_scc1 L_v_f5
    buffer_load_dwordx4 v[212:215], v7, s[8:11], s54 offen offset:1024 nt
L_v_f5:
    buffer_load_dwordx4 v[216:219], v7, s[8:11], s54 offen offset:2048 nt
    buffer_load_dwordx4 v[220:223], v7, s[8:11], s54 offen offset:3072 nt
    buffer_load_dwordx4 v[224:227], v8, s[8:11], s54 offen offset:0 nt
    buffer_load_dwordx4 v[228:231], v8, s[8:11], s54 offen offset:1024 nt
    v_mov_b32 v48, 0
    s_waitcnt lgkmcnt(0)
    s_barrier
    ds_read_b128 v[76:79], v48 offset:4096
    ds_read_b128 v[80:83], v48 offset:4112
    s_waitcnt lgkmcnt(0)
    v_min_f32 v48, v76, v78
    v_min3_f32 v48, v48, v80, v82
    v_sub_f32 v76, v48, v76
    v_sub_f32 v78, v48, v78
    v_sub_f32 v80, v48, v80
    v_sub_f32 v82, v48, v82
    v_sub_f32 v60, v48, v64
    v_exp_f32 v76, v76
    v_exp_f32 v78, v78
    v_exp_f32 v80, v80
    v_exp_f32 v82, v82
    v_exp_f32 v60, v60
    v_mul_f32 v49, v76, v77
    v_fmac_f32 v49, v78, v79
    v_fmac_f32 v49, v80, v81
    v_fmac_f32 v49, v82, v83
    v_rcp_f32 v49, v49
    s_nop 0
    v_mul_f32 v60, v60, v49
    v_accvgpr_mov_b32 a128, a0
    v_accvgpr_mov_b32 a129, a1
    s_waitcnt vmcnt(9)
    buffer_load_dwordx4 v[232:235], v8, s[8:11], s54 offen offset:2048 nt
    v_mfma_f32_16x16x32_bf16 v[28:31], v[18:21], v[192:195], v[28:31]
    v_and_b32_dpp v22, v67, v14 row_newbcast:8 row_mask:0xf bank_mask:0xf
    v_and_b32_dpp v23, v67, v15 row_newbcast:8 row_mask:0xf bank_mask:0xf
    v_and_b32_dpp v24, v67, v16 row_newbcast:8 row_mask:0xf bank_mask:0xf
    v_and_b32_dpp v25, v67, v17 row_newbcast:8 row_mask:0xf bank_mask:0xf
    s_waitcnt vmcnt(9)
    buffer_load_dwordx4 v[236:239], v8, s[8:11], s54 offen offset:3072 nt
    v_mfma_f32_16x16x32_bf16 v[28:31], v[22:25], v[196:199], v[28:31]
    v_and_b32_dpp v18, v67, v14 row_newbcast:4 row_mask:0xf bank_mask:0xf
    v_and_b32_dpp v19, v67, v15 row_newbcast:4 row_mask:0xf bank_mask:0xf
    v_and_b32_dpp v20, v67, v16 row_newbcast:4 row_mask:0xf bank_mask:0xf
    v_and_b32_dpp v21, v67, v17 row_newbcast:4 row_mask:0xf bank_mask:0xf
    s_waitcnt vmcnt(9)
    buffer_load_dwordx4 v[240:243], v9, s[8:11], s54 offen offset:0 nt
    v_mfma_f32_16x16x32_bf16 v[28:31], v[18:21], v[200:203], v[28:31]
    v_and_b32_dpp v22, v67, v14 row_newbcast:12 row_mask:0xf bank_mask:0xf
    v_and_b32_dpp v23, v67, v15 row_newbcast:12 row_mask:0xf bank_mask:0xf
    v_and_b32_dpp v24, v67, v16 row_newbcast:12 row_mask:0xf bank_mask:0xf
    v_and_b32_dpp v25, v67, v17 row_newbcast:12 row_mask:0xf bank_mask:0xf
    s_waitcnt vmcnt(9)
    buffer_load_dwordx4 v[244:247], v9, s[8:11], s54 offen offset:1024 nt
    v_mfma_f32_16x16x32_bf16 v[28:31], v[22:25], v[204:207], v[28:31]
    v_and_b32_dpp v18, v67, v14 row_newbcast:2 row_mask:0xf bank_mask:0xf
    v_and_b32_dpp v19, v67, v15 row_newbcast:2 row_mask:0xf bank_mask:0xf
    v_and_b32_dpp v20, v67, v16 row_newbcast:2 row_mask:0xf bank_mask:0xf
    v_and_b32_dpp v21, v67, v17 row_newbcast:2 row_mask:0xf bank_mask:0xf
    s_waitcnt vmcnt(9)
    buffer_load_dwordx4 v[248:251], v9, s[8:11], s54 offen offset:2048 nt
    v_mfma_f32_16x16x32_bf16 v[28:31], v[18:21], v[208:211], v[28:31]
    v_and_b32_dpp v22, v67, v14 row_newbcast:10 row_mask:0xf bank_mask:0xf
    v_and_b32_dpp v23, v67, v15 row_newbcast:10 row_mask:0xf bank_mask:0xf
    v_and_b32_dpp v24, v67, v16 row_newbcast:10 row_mask:0xf bank_mask:0xf
    v_and_b32_dpp v25, v67, v17 row_newbcast:10 row_mask:0xf bank_mask:0xf
    s_waitcnt vmcnt(9)
    buffer_load_dwordx4 v[252:255], v9, s[8:11], s54 offen offset:3072 nt
    v_mfma_f32_16x16x32_bf16 v[28:31], v[22:25], v[212:215], v[28:31]
    v_and_b32_dpp v18, v67, v14 row_newbcast:6 row_mask:0xf bank_mask:0xf
    v_and_b32_dpp v19, v67, v15 row_newbcast:6 row_mask:0xf bank_mask:0xf
    v_and_b32_dpp v20, v67, v16 row_newbcast:6 row_mask:0xf bank_mask:0xf
    v_and_b32_dpp v21, v67, v17 row_newbcast:6 row_mask:0xf bank_mask:0xf
    s_waitcnt vmcnt(9)
    s_nop 0
    v_mfma_f32_16x16x32_bf16 v[28:31], v[18:21], v[216:219], v[28:31]
    v_and_b32_dpp v22, v67, v14 row_newbcast:14 row_mask:0xf bank_mask:0xf
    v_and_b32_dpp v23, v67, v15 row_newbcast:14 row_mask:0xf bank_mask:0xf
    v_and_b32_dpp v24, v67, v16 row_newbcast:14 row_mask:0xf bank_mask:0xf
    v_and_b32_dpp v25, v67, v17 row_newbcast:14 row_mask:0xf bank_mask:0xf
    s_waitcnt vmcnt(8)
    s_nop 0
    v_mfma_f32_16x16x32_bf16 v[28:31], v[22:25], v[220:223], v[28:31]
    v_and_b32_dpp v18, v67, v14 row_newbcast:1 row_mask:0xf bank_mask:0xf
    v_and_b32_dpp v19, v67, v15 row_newbcast:1 row_mask:0xf bank_mask:0xf
    v_and_b32_dpp v20, v67, v16 row_newbcast:1 row_mask:0xf bank_mask:0xf
    v_and_b32_dpp v21, v67, v17 row_newbcast:1 row_mask:0xf bank_mask:0xf
    s_waitcnt vmcnt(7)
    s_nop 0
    v_mfma_f32_16x16x32_bf16 v[28:31], v[18:21], v[224:227], v[28:31]
    v_and_b32_dpp v22, v67, v14 row_newbcast:9 row_mask:0xf bank_mask:0xf
    v_and_b32_dpp v23, v67, v15 row_newbcast:9 row_mask:0xf bank_mask:0xf
    v_and_b32_dpp v24, v67, v16 row_newbcast:9 row_mask:0xf bank_mask:0xf
    v_and_b32_dpp v25, v67, v17 row_newbcast:9 row_mask:0xf bank_mask:0xf
    s_waitcnt vmcnt(6)
    s_nop 0
    v_mfma_f32_16x16x32_bf16 v[28:31], v[22:25], v[228:231], v[28:31]
    v_and_b32_dpp v18, v67, v14 row_newbcast:5 row_mask:0xf bank_mask:0xf
    v_and_b32_dpp v19, v67, v15 row_newbcast:5 row_mask:0xf bank_mask:0xf
    v_and_b32_dpp v20, v67, v16 row_newbcast:5 row_mask:0xf bank_mask:0xf
    v_and_b32_dpp v21, v67, v17 row_newbcast:5 row_mask:0xf bank_mask:0xf
    s_waitcnt vmcnt(5)
    s_nop 0
    v_mfma_f32_16x16x32_bf16 v[28:31], v[18:21], v[232:235], v[28:31]
    v_and_b32_dpp v22, v67, v14 row_newbcast:13 row_mask:0xf bank_mask:0xf
    v_and_b32_dpp v23, v67, v15 row_newbcast:13 row_mask:0xf bank_mask:0xf
    v_and_b32_dpp v24, v67, v16 row_newbcast:13 row_mask:0xf bank_mask:0xf
    v_and_b32_dpp v25, v67, v17 row_newbcast:13 row_mask:0xf bank_mask:0xf
    s_waitcnt vmcnt(4)
    s_nop 0
    v_mfma_f32_16x16x32_bf16 v[28:31], v[22:25], v[236:239], v[28:31]
    v_and_b32_dpp v18, v67, v14 row_newbcast:3 row_mask:0xf bank_mask:0xf
    v_and_b32_dpp v19, v67, v15 row_newbcast:3 row_mask:0xf bank_mask:0xf
    v_and_b32_dpp v20, v67, v16 row_newbcast:3 row_mask:0xf bank_mask:0xf
    v_and_b32_dpp v21, v67, v17 row_newbcast:3 row_mask:0xf bank_mask:0xf
    s_waitcnt vmcnt(3)
    s_nop 0
    v_mfma_f32_16x16x32_bf16 v[28:31], v[18:21], v[240:243], v[28:31]
    v_and_b32_dpp v22, v67, v14 row_newbcast:11 row_mask:0xf bank_mask:0xf
    v_and_b32_dpp v23, v67, v15 row_newbcast:11 row_mask:0xf bank_mask:0xf
    v_and_b32_dpp v24, v67, v16 row_newbcast:11 row_mask:0xf bank_mask:0xf
    v_and_b32_dpp v25, v67, v17 row_newbcast:11 row_mask:0xf bank_mask:0xf
    s_waitcnt vmcnt(2)
    s_nop 0
    v_mfma_f32_16x16x32_bf16 v[28:31], v[22:25], v[244:247], v[28:31]
    v_and_b32_dpp v18, v67, v14 row_newbcast:7 row_mask:0xf bank_mask:0xf
    v_and_b32_dpp v19, v67, v15 row_newbcast:7 row_mask:0xf bank_mask:0xf
    v_and_b32_dpp v20, v67, v16 row_newbcast:7 row_mask:0xf bank_mask:0xf
    v_and_b32_dpp v21, v67, v17 row_newbcast:7 row_mask:0xf bank_mask:0xf
    s_waitcnt vmcnt(1)
    s_nop 0
    v_mfma_f32_16x16x32_bf16 v[28:31], v[18:21], v[248:251], v[28:31]
    v_and_b32_dpp v22, v67, v14 row_newbcast:15 row_mask:0xf bank_mask:0xf
    v_and_b32_dpp v23, v67, v15 row_newbcast:15 row_mask:0xf bank_mask:0xf
    v_and_b32_dpp v24, v67, v16 row_newbcast:15 row_mask:0xf bank_mask:0xf
    v_and_b32_dpp v25, v67, v17 row_newbcast:15 row_mask:0xf bank_mask:0xf
    s_waitcnt vmcnt(0)
    s_nop 0
    v_mfma_f32_16x16x32_bf16 v[28:31], v[22:25], v[252:255], v[28:31]
L_v_end:
    s_nop 7
    v_mul_f32 v28, v28, v60
    v_mul_f32 v29, v29, v60
    v_mul_f32 v30, v30, v60
    v_mul_f32 v31, v31, v60
    s_mov_b32 exec_hi, 0
    ds_write_b128 v26, v[28:31] offset:2048
    s_mov_b64 exec, -1
    s_waitcnt lgkmcnt(0)
    s_barrier
    ds_read2st64_b32 v[84:85], v27 offset0:8 offset1:9
    ds_read2st64_b32 v[86:87], v27 offset0:10 offset1:11
    ds_read2st64_b32 v[88:89], v27 offset0:12 offset1:13
    ds_read2st64_b32 v[90:91], v27 offset0:14 offset1:15
    s_waitcnt lgkmcnt(2)
    v_add_f32 v84, v84, v86
    v_add_f32 v85, v85, v87
    s_waitcnt lgkmcnt(0)
    v_add_f32 v88, v88, v90
    v_add_f32 v89, v89, v91
    v_add_f32 v56, v84, v88
    v_add_f32 v57, v85, v89
    v_cvt_pk_bf16_f32 v66, v56, v56
    v_cvt_pk_bf16_f32 v67, v57, v57
    s_nop 0
    v_and_b32_dpp v128, v66, v14 row_newbcast:0 row_mask:0xf bank_mask:0xf
    v_and_b32_dpp v129, v66, v15 row_newbcast:0 row_mask:0xf bank_mask:0xf
    v_and_b32_dpp v130, v66, v16 row_newbcast:1 row_mask:0xf bank_mask:0xf
    v_and_b32_dpp v131, v66, v17 row_newbcast:1 row_mask:0xf bank_mask:0xf
    v_and_b32_dpp v132, v66, v14 row_newbcast:2 row_mask:0xf bank_mask:0xf
    v_and_b32_dpp v133, v66, v15 row_newbcast:2 row_mask:0xf bank_mask:0xf
    v_mfma_f32_16x16x32_bf16 v[76:79], v[128:131], a[2:5], 0
    v_and_b32_dpp v134, v66, v16 row_newbcast:3 row_mask:0xf bank_mask:0xf
    v_and_b32_dpp v135, v66, v17 row_newbcast:3 row_mask:0xf bank_mask:0xf
    v_mfma_f32_16x16x32_bf16 v[28:31], v[130:133], a[6:9], 0
    v_and_b32_dpp v136, v66, v14 row_newbcast:4 row_mask:0xf bank_mask:0xf
    v_and_b32_dpp v137, v66, v15 row_newbcast:4 row_mask:0xf bank_mask:0xf
    v_mfma_f32_16x16x32_bf16 v[76:79], v[132:135], a[10:13], v[76:79]
    v_and_b32_dpp v138, v66, v16 row_newbcast:5 row_mask:0xf bank_mask:0xf
    v_and_b32_dpp v139, v66, v17 row_newbcast:5 row_mask:0xf bank_mask:0xf
    v_mfma_f32_16x16x32_bf16 v[28:31], v[134:137], a[14:17], v[28:31]
    v_and_b32_dpp v140, v66, v14 row_newbcast:6 row_mask:0xf bank_mask:0xf
    v_and_b32_dpp v141, v66, v15 row_newbcast:6 row_mask:0xf bank_mask:0xf
    v_mfma_f32_16x16x32_bf16 v[76:79], v[136:139], a[18:21], v[76:79]
    v_and_b32_dpp v142, v66, v16 row_newbcast:7 row_mask:0xf bank_mask:0xf
    v_and_b32_dpp v143, v66, v17 row_newbcast:7 row_mask:0xf bank_mask:0xf
    v_mfma_f32_16x16x32_bf16 v[28:31], v[138:141], a[22:25], v[28:31]
    v_and_b32_dpp v144, v66, v14 row_newbcast:8 row_mask:0xf bank_mask:0xf
    v_and_b32_dpp v145, v66, v15 row_newbcast:8 row_mask:0xf bank_mask:0xf
    v_mfma_f32_16x16x32_bf16 v[76:79], v[140:143], a[26:29], v[76:79]
    v_and_b32_dpp v146, v66, v16 row_newbcast:9 row_mask:0xf bank_mask:0xf
    v_and_b32_dpp v147, v66, v17 row_newbcast:9 row_mask:0xf bank_mask:0xf
    v_mfma_f32_16x16x32_bf16 v[28:31], v[142:145], a[30:33], v[28:31]
    v_and_b32_dpp v148, v66, v14 row_newbcast:10 row_mask:0xf bank_mask:0xf
    v_and_b32_dpp v149, v66, v15 row_newbcast:10 row_mask:0xf bank_mask:0xf
    v_mfma_f32_16x16x32_bf16 v[76:79], v[144:147], a[34:37], v[76:79]
    v_and_b32_dpp v150, v66, v16 row_newbcast:11 row_mask:0xf bank_mask:0xf
    v_and_b32_dpp v151, v66, v17 row_newbcast:11 row_mask:0xf bank_mask:0xf
    v_mfma_f32_16x16x32_bf16 v[28:31], v[146:149], a[38:41], v[28:31]
    v_and_b32_dpp v152, v66, v14 row_newbcast:12 row_mask:0xf bank_mask:0xf
    v_and_b32_dpp v153, v66, v15 row_newbcast:12 row_mask:0xf bank_mask:0xf
    v_mfma_f32_16x16x32_bf16 v[76:79], v[148:151], a[42:45], v[76:79]
    v_and_b32_dpp v154, v66, v16 row_newbcast:13 row_mask:0xf bank_mask:0xf
    v_and_b32_dpp v155, v66, v17 row_newbcast:13 row_mask:0xf bank_mask:0xf
    v_mfma_f32_16x16x32_bf16 v[28:31], v[150:153], a[46:49], v[28:31]
    v_and_b32_dpp v156, v66, v14 row_newbcast:14 row_mask:0xf bank_mask:0xf
    v_and_b32_dpp v157, v66, v15 row_newbcast:14 row_mask:0xf bank_mask:0xf
    v_mfma_f32_16x16x32_bf16 v[76:79], v[152:155], a[50:53], v[76:79]
    v_and_b32_dpp v158, v66, v16 row_newbcast:15 row_mask:0xf bank_mask:0xf
    v_and_b32_dpp v159, v66, v17 row_newbcast:15 row_mask:0xf bank_mask:0xf
    v_mfma_f32_16x16x32_bf16 v[28:31], v[154:157], a[54:57], v[28:31]
    v_and_b32_dpp v160, v67, v14 row_newbcast:0 row_mask:0xf bank_mask:0xf
    v_and_b32_dpp v161, v67, v15 row_newbcast:0 row_mask:0xf bank_mask:0xf
    v_mfma_f32_16x16x32_bf16 v[76:79], v[156:159], a[58:61], v[76:79]
    v_and_b32_dpp v162, v67, v16 row_newbcast:1 row_mask:0xf bank_mask:0xf
    v_and_b32_dpp v163, v67, v17 row_newbcast:1 row_mask:0xf bank_mask:0xf
    v_mfma_f32_16x16x32_bf16 v[28:31], v[158:161], a[62:65], v[28:31]
    v_and_b32_dpp v164, v67, v14 row_newbcast:2 row_mask:0xf bank_mask:0xf
    v_and_b32_dpp v165, v67, v15 row_newbcast:2 row_mask:0xf bank_mask:0xf
    v_mfma_f32_16x16x32_bf16 v[76:79], v[160:163], a[66:69], v[76:79]
    v_and_b32_dpp v166, v67, v16 row_newbcast:3 row_mask:0xf bank_mask:0xf
    v_and_b32_dpp v167, v67, v17 row_newbcast:3 row_mask:0xf bank_mask:0xf
    v_mfma_f32_16x16x32_bf16 v[28:31], v[162:165], a[70:73], v[28:31]
    v_and_b32_dpp v168, v67, v14 row_newbcast:4 row_mask:0xf bank_mask:0xf
    v_and_b32_dpp v169, v67, v15 row_newbcast:4 row_mask:0xf bank_mask:0xf
    v_mfma_f32_16x16x32_bf16 v[76:79], v[164:167], a[74:77], v[76:79]
    v_and_b32_dpp v170, v67, v16 row_newbcast:5 row_mask:0xf bank_mask:0xf
    v_and_b32_dpp v171, v67, v17 row_newbcast:5 row_mask:0xf bank_mask:0xf
    v_mfma_f32_16x16x32_bf16 v[28:31], v[166:169], a[78:81], v[28:31]
    v_and_b32_dpp v172, v67, v14 row_newbcast:6 row_mask:0xf bank_mask:0xf
    v_and_b32_dpp v173, v67, v15 row_newbcast:6 row_mask:0xf bank_mask:0xf
    v_mfma_f32_16x16x32_bf16 v[76:79], v[168:171], a[82:85], v[76:79]
    v_and_b32_dpp v174, v67, v16 row_newbcast:7 row_mask:0xf bank_mask:0xf
    v_and_b32_dpp v175, v67, v17 row_newbcast:7 row_mask:0xf bank_mask:0xf
    v_mfma_f32_16x16x32_bf16 v[28:31], v[170:173], a[86:89], v[28:31]
    v_and_b32_dpp v176, v67, v14 row_newbcast:8 row_mask:0xf bank_mask:0xf
    v_and_b32_dpp v177, v67, v15 row_newbcast:8 row_mask:0xf bank_mask:0xf
    v_mfma_f32_16x16x32_bf16 v[76:79], v[172:175], a[90:93], v[76:79]
    v_and_b32_dpp v178, v67, v16 row_newbcast:9 row_mask:0xf bank_mask:0xf
    v_and_b32_dpp v179, v67, v17 row_newbcast:9 row_mask:0xf bank_mask:0xf
    v_mfma_f32_16x16x32_bf16 v[28:31], v[174:177], a[94:97], v[28:31]
    v_and_b32_dpp v180, v67, v14 row_newbcast:10 row_mask:0xf bank_mask:0xf
    v_and_b32_dpp v181, v67, v15 row_newbcast:10 row_mask:0xf bank_mask:0xf
    v_mfma_f32_16x16x32_bf16 v[76:79], v[176:179], a[98:101], v[76:79]
    v_and_b32_dpp v182, v67, v16 row_newbcast:11 row_mask:0xf bank_mask:0xf
    v_and_b32_dpp v183, v67, v17 row_newbcast:11 row_mask:0xf bank_mask:0xf
    v_mfma_f32_16x16x32_bf16 v[28:31], v[178:181], a[102:105], v[28:31]
    v_and_b32_dpp v184, v67, v14 row_newbcast:12 row_mask:0xf bank_mask:0xf
    v_and_b32_dpp v185, v67, v15 row_newbcast:12 row_mask:0xf bank_mask:0xf
    v_mfma_f32_16x16x32_bf16 v[76:79], v[180:183], a[106:109], v[76:79]
    v_and_b32_dpp v186, v67, v16 row_newbcast:13 row_mask:0xf bank_mask:0xf
    v_and_b32_dpp v187, v67, v17 row_newbcast:13 row_mask:0xf bank_mask:0xf
    v_mfma_f32_16x16x32_bf16 v[28:31], v[182:185], a[110:113], v[28:31]
    v_and_b32_dpp v188, v67, v14 row_newbcast:14 row_mask:0xf bank_mask:0xf
    v_and_b32_dpp v189, v67, v15 row_newbcast:14 row_mask:0xf bank_mask:0xf
    v_mfma_f32_16x16x32_bf16 v[76:79], v[184:187], a[114:117], v[76:79]
    v_and_b32_dpp v190, v67, v16 row_newbcast:15 row_mask:0xf bank_mask:0xf
    v_and_b32_dpp v191, v67, v17 row_newbcast:15 row_mask:0xf bank_mask:0xf
    v_mfma_f32_16x16x32_bf16 v[28:31], v[186:189], a[118:121], v[28:31]
    v_and_b32_dpp v192, v66, v14 row_newbcast:0 row_mask:0xf bank_mask:0xf
    v_and_b32_dpp v193, v66, v15 row_newbcast:0 row_mask:0xf bank_mask:0xf
    v_mfma_f32_16x16x32_bf16 v[76:79], v[188:191], a[122:125], v[76:79]
    s_nop 0
    v_mfma_f32_16x16x32_bf16 v[28:31], v[190:193], a[126:129], v[28:31]
    s_nop 5
    v_permlane16_swap_b32 v76, v76
    v_permlane16_swap_b32 v77, v77
    v_permlane16_swap_b32 v78, v78
    v_permlane16_swap_b32 v79, v79
    v_add_f32 v28, v28, v76
    v_add_f32 v29, v29, v77
    v_add_f32 v30, v30, v78
    v_add_f32 v31, v31, v79
    s_mov_b32 exec_hi, 0
    v_min_u32 v28, -2, v28
    v_min_u32 v29, -2, v29
    v_min_u32 v30, -2, v30
    v_min_u32 v31, -2, v31
    buffer_store_dwordx4 v[28:31], v68, s[32:35], 0 offen sc1
    s_mov_b64 exec, -1
    buffer_load_dwordx4 a[132:135], v58, s[40:43], s96 offen
    buffer_load_dwordx4 a[132:135], v58, s[40:43], s97 offen
    buffer_load_dwordx4 a[132:135], v58, s[44:47], s96 offen
    buffer_load_dwordx4 a[132:135], v58, s[44:47], s97 offen
    buffer_load_dwordx4 a[132:135], v59, s[20:23], s98 offen
    buffer_load_dwordx4 a[132:135], v59, s[20:23], s99 offen
    s_cmp_eq_u32 s6, 2
    s_cbranch_scc1 L_s2
    s_and_b32 s58, s7, 1
    s_cbranch_scc0 L_fin
    s_cmp_eq_u32 s7, 1
    s_cbranch_scc0 L_dmaD
    v_lshrrev_b32 v62, 2, v1
    s_movk_i32 s58, 3584
    v_mul_u32_u24 v62, s58, v62
    v_and_b32 v63, 3, v1
    v_lshl_add_u32 v62, v63, 4, v62
    s_lshl_b32 s58, s89, 6
    v_add_u32 v62, s58, v62
    s_mul_i32 s96, s3, 458752
    s_mov_b32 s97, s96
    s_lshl_b32 s98, s3, 13
    s_add_u32 s98, s98, 24576
    s_add_u32 s99, s98, 32768
    s_mov_b32 s100, 57344
    s_mov_b32 s101, 1024
    s_mov_b32 s93, 8
    s_branch L_dma
L_dmaD:
    v_lshrrev_b32 v62, 1, v1
    v_lshlrev_b32 v62, 10, v62
    v_and_b32 v63, 1, v1
    v_lshl_add_u32 v62, v63, 4, v62
    s_lshl_b32 s58, s89, 5
    v_add_u32 v62, s58, v62
    s_mov_b32 s40, s80
    s_mov_b32 s41, s81
    s_mov_b32 s42, 1835008
    s_mov_b32 s44, s80
    s_mov_b32 s45, s81
    s_mov_b32 s46, 1835008
    s_mul_i32 s96, s3, 458752
    s_add_u32 s97, s96, 32768
    s_mul_i32 s98, s3, 14336
    s_add_u32 s98, s98, 24576
    s_add_u32 s99, s98, 1024
    s_mov_b32 s100, 65536
    s_mov_b32 s101, 2048
    s_mov_b32 s93, 7
L_dma:
    s_mov_b32 m0, s98
    s_sub_u32 s93, s93, 1
    buffer_load_dwordx4 v62, s[40:43], s96 offen  lds
    s_mov_b32 m0, s99
    s_add_u32 s96, s96, s100
    buffer_load_dwordx4 v62, s[44:47], s97 offen  lds
    s_add_u32 s97, s97, s100
    s_add_u32 s98, s98, s101
    s_add_u32 s99, s99, s101
    s_cmp_lg_u32 s93, 0
    s_cbranch_scc1 L_dma
    v_and_b32 v27, 7, v75
    v_lshlrev_b32 v63, 4, v27
    v_lshl_add_u32 v63, v74, 7, v63
    s_lshl_b32 s58, s3, 9
    v_add_u32 v26, s58, v63
    v_lshrrev_b32 v60, 2, v75
    v_lshl_add_u32 v60, v74, 4, v60
    v_and_b32 v61, 3, v1
    s_cmp_eq_u32 s7, 3
    s_cbranch_scc1 L_s4
    v_lshlrev_b32 v60, 6, v60
    v_lshrrev_b32 v49, 1, v61
    v_lshl_add_u32 v60, v49, 15, v60
    v_and_b32 v49, 1, v61
    v_lshl_add_u32 v60, v49, 3, v60
    s_lshl_b32 s58, s3, 13
    s_add_u32 s58, s58, 24576
    v_add_u32 v60, s58, v60
    v_mov_b32 v112, 0x3f803f80
    v_mov_b32 v113, 0x3f803f80
    v_mov_b32 v114, 0x3f803f80
    v_mov_b32 v115, 0x3f803f80
    v_lshrrev_b32 v62, 1, v74
    v_lshlrev_b32 v62, 9, v62
    v_bfe_u32 v49, v75, 1, 2
    v_lshl_add_u32 v62, v49, 7, v62
    v_and_b32 v49, 1, v75
    v_lshl_add_u32 v62, v49, 6, v62
    v_and_b32 v49, 1, v74
    v_lshl_add_u32 v62, v49, 5, v62
    v_lshrrev_b32 v49, 3, v75
    v_lshl_add_u32 v62, v49, 4, v62
    s_mov_b32 s58, 81920
    v_mad_u32_u24 v26, v49, s58, v26
    s_lshl_b32 s58, s3, 11
    v_add_u32 v63, s58, v63
    v_lshrrev_b32 v49, 1, v74
    v_lshlrev_b32 v49, 2, v49
    v_lshlrev_b32 v61, 5, v27
    v_add_u32 v49, v49, v61
    s_lshl_b32 s58, s3, 3
    v_add_u32 v49, s58, v49
    s_lshl_b32 s59, s3, 11
    s_add_u32 s59, s59, 524288
    s_waitcnt vmcnt(8)
    ds_read_b64_tr_b16 v[128:129], v60 offset:0
    ds_read_b64_tr_b16 v[130:131], v60 offset:256
    ds_read_b64_tr_b16 v[132:133], v60 offset:512
    ds_read_b64_tr_b16 v[134:135], v60 offset:768
    ds_read_b64_tr_b16 v[144:145], v60 offset:16
    ds_read_b64_tr_b16 v[146:147], v60 offset:272
    ds_read_b64_tr_b16 v[148:149], v60 offset:528
    ds_read_b64_tr_b16 v[150:151], v60 offset:784
    ds_read_b64_tr_b16 v[160:161], v60 offset:32
    ds_read_b64_tr_b16 v[162:163], v60 offset:288
    ds_read_b64_tr_b16 v[164:165], v60 offset:544
    ds_read_b64_tr_b16 v[166:167], v60 offset:800
    s_waitcnt lgkmcnt(6)
    ds_read_b64_tr_b16 v[176:177], v60 offset:48
    ds_read_b64_tr_b16 v[178:179], v60 offset:304
    ds_read_b64_tr_b16 v[180:181], v60 offset:560
    ds_read_b64_tr_b16 v[182:183], v60 offset:816
    s_waitcnt lgkmcnt(0)
    s_waitcnt vmcnt(0)
    ds_read_b64_tr_b16 v[136:137], v60 offset:4096
    ds_read_b64_tr_b16 v[138:139], v60 offset:4352
    ds_read_b64_tr_b16 v[140:141], v60 offset:4608
    ds_read_b64_tr_b16 v[142:143], v60 offset:4864
    ds_read_b64_tr_b16 v[152:153], v60 offset:4112
    ds_read_b64_tr_b16 v[154:155], v60 offset:4368
    ds_read_b64_tr_b16 v[156:157], v60 offset:4624
    ds_read_b64_tr_b16 v[158:159], v60 offset:4880
    ds_read_b64_tr_b16 v[168:169], v60 offset:4128
    ds_read_b64_tr_b16 v[170:171], v60 offset:4384
    ds_read_b64_tr_b16 v[172:173], v60 offset:4640
    ds_read_b64_tr_b16 v[174:175], v60 offset:4896
    s_waitcnt lgkmcnt(6)
    ds_read_b64_tr_b16 v[184:185], v60 offset:4144
    ds_read_b64_tr_b16 v[186:187], v60 offset:4400
    ds_read_b64_tr_b16 v[188:189], v60 offset:4656
    ds_read_b64_tr_b16 v[190:191], v60 offset:4912
    s_mov_b32 s88, 200000
    buffer_load_dwordx4 v[76:79], v62, s[32:35], s59 offen offset:0 sc1
    buffer_load_dwordx4 v[80:83], v62, s[32:35], s59 offen offset:1024 sc1
    s_waitcnt lgkmcnt(0)
    v_mfma_f32_16x16x32_bf16 v[224:227], v[128:131], v[112:115], 0
    v_mfma_f32_16x16x32_bf16 v[228:231], v[144:147], v[112:115], 0
    v_mfma_f32_16x16x32_bf16 v[232:235], v[160:163], v[112:115], 0
    v_mfma_f32_16x16x32_bf16 v[236:239], v[176:179], v[112:115], 0
    v_mfma_f32_16x16x32_bf16 v[224:227], v[132:135], v[112:115], v[224:227]
    v_mfma_f32_16x16x32_bf16 v[228:231], v[148:151], v[112:115], v[228:231]
    v_mfma_f32_16x16x32_bf16 v[232:235], v[164:167], v[112:115], v[232:235]
    v_mfma_f32_16x16x32_bf16 v[236:239], v[180:183], v[112:115], v[236:239]
    v_mfma_f32_16x16x32_bf16 v[224:227], v[136:139], v[112:115], v[224:227]
    v_mfma_f32_16x16x32_bf16 v[228:231], v[152:155], v[112:115], v[228:231]
    v_mfma_f32_16x16x32_bf16 v[232:235], v[168:171], v[112:115], v[232:235]
    v_mfma_f32_16x16x32_bf16 v[236:239], v[184:187], v[112:115], v[236:239]
    v_mfma_f32_16x16x32_bf16 v[224:227], v[140:143], v[112:115], v[224:227]
    v_mfma_f32_16x16x32_bf16 v[228:231], v[156:159], v[112:115], v[228:231]
    v_mfma_f32_16x16x32_bf16 v[232:235], v[172:175], v[112:115], v[232:235]
    v_mfma_f32_16x16x32_bf16 v[236:239], v[188:191], v[112:115], v[236:239]
    s_nop 4
    ds_write_b128 v26, v[224:227] offset:16384
    ds_write_b128 v26, v[228:231] offset:18432
    ds_write_b128 v26, v[232:235] offset:20480
    ds_write_b128 v26, v[236:239] offset:22528
L_pH:
    buffer_load_dwordx4 v[84:87], v62, s[32:35], s59 offen offset:0 sc1
    buffer_load_dwordx4 v[88:91], v62, s[32:35], s59 offen offset:1024 sc1
    s_waitcnt vmcnt(2)
    v_max3_u32 v48, v76, v77, v78
    v_max3_u32 v48, v48, v79, v80
    v_max3_u32 v48, v48, v81, v82
    v_max_u32 v48, v48, v83
    v_cmp_eq_u32 vcc, -1, v48
    s_cbranch_vccz L_pH_A
    buffer_load_dwordx4 v[76:79], v62, s[32:35], s59 offen offset:0 sc1
    buffer_load_dwordx4 v[80:83], v62, s[32:35], s59 offen offset:1024 sc1
    s_waitcnt vmcnt(2)
    v_max3_u32 v48, v84, v85, v86
    v_max3_u32 v48, v48, v87, v88
    v_max3_u32 v48, v48, v89, v90
    v_max_u32 v48, v48, v91
    v_cmp_eq_u32 vcc, -1, v48
    s_cbranch_vccz L_pH_B
    s_sub_u32 s88, s88, 1
    s_cbranch_scc0 L_pH
L_pH_B:
    v_mfma_f32_16x16x32_bf16 v[192:195], v[128:131], v[84:87], 0
    v_dot2_f32_bf16 v52, v84, v112, 0
    v_dot2_f32_bf16 v53, v84, v84, 0
    v_mfma_f32_16x16x32_bf16 v[196:199], v[132:135], v[84:87], 0
    v_dot2_f32_bf16 v52, v85, v112, v52
    v_dot2_f32_bf16 v53, v85, v85, v53
    v_mfma_f32_16x16x32_bf16 v[200:203], v[144:147], v[84:87], 0
    v_dot2_f32_bf16 v52, v86, v112, v52
    v_dot2_f32_bf16 v53, v86, v86, v53
    v_mfma_f32_16x16x32_bf16 v[204:207], v[148:151], v[84:87], 0
    v_dot2_f32_bf16 v52, v87, v112, v52
    v_dot2_f32_bf16 v53, v87, v87, v53
    v_mfma_f32_16x16x32_bf16 v[208:211], v[160:163], v[84:87], 0
    v_dot2_f32_bf16 v52, v88, v112, v52
    v_dot2_f32_bf16 v53, v88, v88, v53
    v_mfma_f32_16x16x32_bf16 v[212:215], v[164:167], v[84:87], 0
    v_dot2_f32_bf16 v52, v89, v112, v52
    v_dot2_f32_bf16 v53, v89, v89, v53
    v_mfma_f32_16x16x32_bf16 v[216:219], v[176:179], v[84:87], 0
    v_dot2_f32_bf16 v52, v90, v112, v52
    v_dot2_f32_bf16 v53, v90, v90, v53
    v_mfma_f32_16x16x32_bf16 v[220:223], v[180:183], v[84:87], 0
    v_dot2_f32_bf16 v52, v91, v112, v52
    v_dot2_f32_bf16 v53, v91, v91, v53
    v_mfma_f32_16x16x32_bf16 v[192:195], v[136:139], v[88:91], v[192:195]
    v_mfma_f32_16x16x32_bf16 v[196:199], v[140:143], v[88:91], v[196:199]
    v_add_f32_dpp v52, v52, v52 row_ror:8 row_mask:0xf bank_mask:0xf
    v_add_f32_dpp v53, v53, v53 row_ror:8 row_mask:0xf bank_mask:0xf
    v_mfma_f32_16x16x32_bf16 v[200:203], v[152:155], v[88:91], v[200:203]
    v_mfma_f32_16x16x32_bf16 v[204:207], v[156:159], v[88:91], v[204:207]
    v_permlane32_swap_b32 v52, v53
    v_add_f32 v52, v52, v53
    v_mov_b32 v53, v52
    v_mfma_f32_16x16x32_bf16 v[208:211], v[168:171], v[88:91], v[208:211]
    v_mfma_f32_16x16x32_bf16 v[212:215], v[172:175], v[88:91], v[212:215]
    v_permlane16_swap_b32 v52, v53
    v_add_f32 v52, v52, v53
    ds_write_b32 v49, v52 offset:4160
    v_mfma_f32_16x16x32_bf16 v[216:219], v[184:187], v[88:91], v[216:219]
    v_mfma_f32_16x16x32_bf16 v[220:223], v[188:191], v[88:91], v[220:223]
    s_branch L_pH_done
L_pH_A:
    v_mfma_f32_16x16x32_bf16 v[192:195], v[128:131], v[76:79], 0
    v_dot2_f32_bf16 v52, v76, v112, 0
    v_dot2_f32_bf16 v53, v76, v76, 0
    v_mfma_f32_16x16x32_bf16 v[196:199], v[132:135], v[76:79], 0
    v_dot2_f32_bf16 v52, v77, v112, v52
    v_dot2_f32_bf16 v53, v77, v77, v53
    v_mfma_f32_16x16x32_bf16 v[200:203], v[144:147], v[76:79], 0
    v_dot2_f32_bf16 v52, v78, v112, v52
    v_dot2_f32_bf16 v53, v78, v78, v53
    v_mfma_f32_16x16x32_bf16 v[204:207], v[148:151], v[76:79], 0
    v_dot2_f32_bf16 v52, v79, v112, v52
    v_dot2_f32_bf16 v53, v79, v79, v53
    v_mfma_f32_16x16x32_bf16 v[208:211], v[160:163], v[76:79], 0
    v_dot2_f32_bf16 v52, v80, v112, v52
    v_dot2_f32_bf16 v53, v80, v80, v53
    v_mfma_f32_16x16x32_bf16 v[212:215], v[164:167], v[76:79], 0
    v_dot2_f32_bf16 v52, v81, v112, v52
    v_dot2_f32_bf16 v53, v81, v81, v53
    v_mfma_f32_16x16x32_bf16 v[216:219], v[176:179], v[76:79], 0
    v_dot2_f32_bf16 v52, v82, v112, v52
    v_dot2_f32_bf16 v53, v82, v82, v53
    v_mfma_f32_16x16x32_bf16 v[220:223], v[180:183], v[76:79], 0
    v_dot2_f32_bf16 v52, v83, v112, v52
    v_dot2_f32_bf16 v53, v83, v83, v53
    v_mfma_f32_16x16x32_bf16 v[192:195], v[136:139], v[80:83], v[192:195]
    v_mfma_f32_16x16x32_bf16 v[196:199], v[140:143], v[80:83], v[196:199]
    v_add_f32_dpp v52, v52, v52 row_ror:8 row_mask:0xf bank_mask:0xf
    v_add_f32_dpp v53, v53, v53 row_ror:8 row_mask:0xf bank_mask:0xf
    v_mfma_f32_16x16x32_bf16 v[200:203], v[152:155], v[80:83], v[200:203]
    v_mfma_f32_16x16x32_bf16 v[204:207], v[156:159], v[80:83], v[204:207]
    v_permlane32_swap_b32 v52, v53
    v_add_f32 v52, v52, v53
    v_mov_b32 v53, v52
    v_mfma_f32_16x16x32_bf16 v[208:211], v[168:171], v[80:83], v[208:211]
    v_mfma_f32_16x16x32_bf16 v[212:215], v[172:175], v[80:83], v[212:215]
    v_permlane16_swap_b32 v52, v53
    v_add_f32 v52, v52, v53
    ds_write_b32 v49, v52 offset:4160
    v_mfma_f32_16x16x32_bf16 v[216:219], v[184:187], v[80:83], v[216:219]
    v_mfma_f32_16x16x32_bf16 v[220:223], v[188:191], v[80:83], v[220:223]
L_pH_done:
    v_add_f32_dpp v192, v196, v192 row_ror:8 row_mask:0xf bank_mask:0xf
    v_add_f32_dpp v193, v197, v193 row_ror:8 row_mask:0xf bank_mask:0xf
    v_add_f32_dpp v194, v198, v194 row_ror:8 row_mask:0xf bank_mask:0xf
    v_add_f32_dpp v195, v199, v195 row_ror:8 row_mask:0xf bank_mask:0xf
    ds_write_b128 v26, v[192:195] offset:8192
    v_add_f32_dpp v200, v204, v200 row_ror:8 row_mask:0xf bank_mask:0xf
    v_add_f32_dpp v201, v205, v201 row_ror:8 row_mask:0xf bank_mask:0xf
    v_add_f32_dpp v202, v206, v202 row_ror:8 row_mask:0xf bank_mask:0xf
    v_add_f32_dpp v203, v207, v203 row_ror:8 row_mask:0xf bank_mask:0xf
    ds_write_b128 v26, v[200:203] offset:10240
    v_add_f32_dpp v208, v212, v208 row_ror:8 row_mask:0xf bank_mask:0xf
    v_add_f32_dpp v209, v213, v209 row_ror:8 row_mask:0xf bank_mask:0xf
    v_add_f32_dpp v210, v214, v210 row_ror:8 row_mask:0xf bank_mask:0xf
    v_add_f32_dpp v211, v215, v211 row_ror:8 row_mask:0xf bank_mask:0xf
    ds_write_b128 v26, v[208:211] offset:12288
    v_add_f32_dpp v216, v220, v216 row_ror:8 row_mask:0xf bank_mask:0xf
    v_add_f32_dpp v217, v221, v217 row_ror:8 row_mask:0xf bank_mask:0xf
    v_add_f32_dpp v218, v222, v218 row_ror:8 row_mask:0xf bank_mask:0xf
    v_add_f32_dpp v219, v223, v219 row_ror:8 row_mask:0xf bank_mask:0xf
    ds_write_b128 v26, v[216:219] offset:14336
    s_waitcnt lgkmcnt(0)
    s_barrier
    ds_read_b128 v[92:95], v61 offset:4160
    ds_read_b128 v[96:99], v61 offset:4176
    ds_read_b128 v[224:227], v63 offset:16384
    ds_read_b128 v[228:231], v63 offset:16896
    ds_read_b128 v[232:235], v63 offset:17408
    ds_read_b128 v[236:239], v63 offset:17920
    ds_read_b128 v[116:119], v63 offset:8192
    ds_read_b128 v[120:123], v63 offset:8704
    ds_read_b128 v[124:127], v63 offset:9216
    ds_read_b128 v[128:131], v63 offset:9728
    s_waitcnt lgkmcnt(8)
    v_add_f32 v92, v92, v94
    v_add_f32 v96, v96, v98
    v_add_f32 v93, v93, v95
    v_add_f32 v97, v97, v99
    v_add_f32 v52, v92, v96
    v_add_f32 v53, v93, v97
    v_mul_f32 v52, 0x3b000000, v52
    v_mul_f32 v53, 0x3b000000, v53
    v_fma_f32 v53, -v52, v52, v53
    v_max_f32 v53, 0, v53
    v_cvt_pk_bf16_f32 v53, v53, v53
    v_and_b32 v53, 0xffff0000, v53
    v_cvt_pk_bf16_f32 v52, v52, v52
    v_and_b32 v52, 0xffff0000, v52
    v_add_f32 v53, 0x3727c5ac, v53
    v_cvt_pk_bf16_f32 v53, v53, v53
    v_and_b32 v53, 0xffff0000, v53
    v_sqrt_f32 v53, v53
    s_waitcnt lgkmcnt(4)
    v_add_f32 v224, v224, v228
    v_add_f32 v232, v232, v236
    v_add_f32 v225, v225, v229
    v_add_f32 v233, v233, v237
    v_add_f32 v226, v226, v230
    v_add_f32 v234, v234, v238
    v_add_f32 v227, v227, v231
    v_add_f32 v235, v235, v239
    v_cvt_pk_bf16_f32 v53, v53, v53
    v_and_b32 v53, 0xffff0000, v53
    v_rcp_f32 v53, v53
    v_add_f32 v108, v224, v232
    v_add_f32 v109, v225, v233
    v_add_f32 v110, v226, v234
    v_add_f32 v111, v227, v235
    s_waitcnt lgkmcnt(0)
    v_add_f32 v116, v116, v120
    v_add_f32 v124, v124, v128
    v_add_f32 v117, v117, v121
    v_add_f32 v125, v125, v129
    v_add_f32 v118, v118, v122
    v_add_f32 v126, v126, v130
    v_add_f32 v119, v119, v123
    v_add_f32 v127, v127, v131
    v_add_f32 v116, v116, v124
    v_add_f32 v117, v117, v125
    v_add_f32 v118, v118, v126
    v_add_f32 v119, v119, v127
    v_fma_f32 v116, -v52, v108, v116
    v_fma_f32 v117, -v52, v109, v117
    v_fma_f32 v118, -v52, v110, v118
    v_fma_f32 v119, -v52, v111, v119
    v_mul_f32 v116, v116, v53
    v_mul_f32 v117, v117, v53
    v_mul_f32 v118, v118, v53
    v_mul_f32 v119, v119, v53
    v_cvt_pk_bf16_f32 v120, v116, v117
    v_cvt_pk_bf16_f32 v121, v118, v119
    s_nop 0
    v_permlane32_swap_b32 v120, v122
    v_permlane32_swap_b32 v121, v123
    v_lshlrev_b32 v116, 16, v120
    v_and_b32 v117, 0xffff0000, v120
    v_lshlrev_b32 v124, 16, v122
    v_and_b32 v125, 0xffff0000, v122
    v_lshlrev_b32 v118, 16, v121
    v_and_b32 v119, 0xffff0000, v121
    v_lshlrev_b32 v126, 16, v123
    v_and_b32 v127, 0xffff0000, v123
    v_max_f32 v116, 0, v116
    v_max_f32 v117, 0, v117
    v_max_f32 v118, 0, v118
    v_max_f32 v119, 0, v119
    v_mul_f32 v116, v116, v124
    v_mul_f32 v117, v117, v125
    v_mul_f32 v118, v118, v126
    v_mul_f32 v119, v119, v127
    v_cvt_pk_bf16_f32 v120, v116, v117
    v_cvt_pk_bf16_f32 v121, v118, v119
    s_mov_b64 exec, 0x00ff00ff
    v_min_u32 v120, -2, v120
    v_min_u32 v121, -2, v121
    buffer_store_dwordx2 v[120:121], v70, s[32:35], 0 offen sc1
    s_branch L_fin
L_s2:
    v_lshlrev_b32 v62, 4, v1
    s_lshl_b32 s59, s89, 13
    s_add_u32 s92, s59, 4096
    v_lshlrev_b32 v50, 16, v71
    v_and_b32 v51, 0xffff0000, v71
    s_mov_b32 s88, 200000
    buffer_load_dwordx4 v[76:79], v62, s[32:35], s59 offen offset:0 sc1
    buffer_load_dwordx4 v[80:83], v62, s[32:35], s59 offen offset:1024 sc1
    buffer_load_dwordx4 v[84:87], v62, s[32:35], s59 offen offset:2048 sc1
    buffer_load_dwordx4 v[88:91], v62, s[32:35], s59 offen offset:3072 sc1
    buffer_load_dwordx4 v[92:95], v62, s[32:35], s92 offen offset:0 sc1
    buffer_load_dwordx4 v[96:99], v62, s[32:35], s92 offen offset:1024 sc1
    buffer_load_dwordx4 v[100:103], v62, s[32:35], s92 offen offset:2048 sc1
    buffer_load_dwordx4 v[104:107], v62, s[32:35], s92 offen offset:3072 sc1
L_pP:
    buffer_load_dwordx4 v[128:131], v62, s[32:35], s59 offen offset:0 sc1
    buffer_load_dwordx4 v[132:135], v62, s[32:35], s59 offen offset:1024 sc1
    buffer_load_dwordx4 v[136:139], v62, s[32:35], s59 offen offset:2048 sc1
    buffer_load_dwordx4 v[140:143], v62, s[32:35], s59 offen offset:3072 sc1
    buffer_load_dwordx4 v[144:147], v62, s[32:35], s92 offen offset:0 sc1
    buffer_load_dwordx4 v[148:151], v62, s[32:35], s92 offen offset:1024 sc1
    buffer_load_dwordx4 v[152:155], v62, s[32:35], s92 offen offset:2048 sc1
    buffer_load_dwordx4 v[156:159], v62, s[32:35], s92 offen offset:3072 sc1
    s_waitcnt vmcnt(8)
    v_max3_u32 v48, v76, v77, v78
    v_max3_u32 v48, v48, v79, v80
    v_max3_u32 v48, v48, v81, v82
    v_max3_u32 v48, v48, v83, v84
    v_max3_u32 v48, v48, v85, v86
    v_max3_u32 v48, v48, v87, v88
    v_max3_u32 v48, v48, v89, v90
    v_max3_u32 v48, v48, v91, v92
    v_max3_u32 v48, v48, v93, v94
    v_max3_u32 v48, v48, v95, v96
    v_max3_u32 v48, v48, v97, v98
    v_max3_u32 v48, v48, v99, v100
    v_max3_u32 v48, v48, v101, v102
    v_max3_u32 v48, v48, v103, v104
    v_max3_u32 v48, v48, v105, v106
    v_max_u32 v48, v48, v107
    v_cmp_eq_u32 vcc, -1, v48
    s_cbranch_vccz L_pP_A
    buffer_load_dwordx4 v[76:79], v62, s[32:35], s59 offen offset:0 sc1
    buffer_load_dwordx4 v[80:83], v62, s[32:35], s59 offen offset:1024 sc1
    buffer_load_dwordx4 v[84:87], v62, s[32:35], s59 offen offset:2048 sc1
    buffer_load_dwordx4 v[88:91], v62, s[32:35], s59 offen offset:3072 sc1
    buffer_load_dwordx4 v[92:95], v62, s[32:35], s92 offen offset:0 sc1
    buffer_load_dwordx4 v[96:99], v62, s[32:35], s92 offen offset:1024 sc1
    buffer_load_dwordx4 v[100:103], v62, s[32:35], s92 offen offset:2048 sc1
    buffer_load_dwordx4 v[104:107], v62, s[32:35], s92 offen offset:3072 sc1
    s_waitcnt vmcnt(8)
    v_max3_u32 v48, v128, v129, v130
    v_max3_u32 v48, v48, v131, v132
    v_max3_u32 v48, v48, v133, v134
    v_max3_u32 v48, v48, v135, v136
    v_max3_u32 v48, v48, v137, v138
    v_max3_u32 v48, v48, v139, v140
    v_max3_u32 v48, v48, v141, v142
    v_max3_u32 v48, v48, v143, v144
    v_max3_u32 v48, v48, v145, v146
    v_max3_u32 v48, v48, v147, v148
    v_max3_u32 v48, v48, v149, v150
    v_max3_u32 v48, v48, v151, v152
    v_max3_u32 v48, v48, v153, v154
    v_max3_u32 v48, v48, v155, v156
    v_max3_u32 v48, v48, v157, v158
    v_max_u32 v48, v48, v159
    v_cmp_eq_u32 vcc, -1, v48
    s_cbranch_vccz L_pP_B
    s_sub_u32 s88, s88, 1
    s_cbranch_scc0 L_pP
L_pP_B:
    v_add_f32 v108, v128, v144
    v_add_f32 v109, v129, v145
    v_add_f32 v110, v130, v146
    v_add_f32 v111, v131, v147
    v_add_f32 v112, v132, v148
    v_add_f32 v113, v133, v149
    v_add_f32 v114, v134, v150
    v_add_f32 v115, v135, v151
    v_add_f32 v116, v136, v152
    v_add_f32 v117, v137, v153
    v_add_f32 v118, v138, v154
    v_add_f32 v119, v139, v155
    v_add_f32 v120, v140, v156
    v_add_f32 v121, v141, v157
    v_add_f32 v122, v142, v158
    v_add_f32 v123, v143, v159
    s_branch L_pP_done
L_pP_A:
    v_add_f32 v108, v76, v92
    v_add_f32 v109, v77, v93
    v_add_f32 v110, v78, v94
    v_add_f32 v111, v79, v95
    v_add_f32 v112, v80, v96
    v_add_f32 v113, v81, v97
    v_add_f32 v114, v82, v98
    v_add_f32 v115, v83, v99
    v_add_f32 v116, v84, v100
    v_add_f32 v117, v85, v101
    v_add_f32 v118, v86, v102
    v_add_f32 v119, v87, v103
    v_add_f32 v120, v88, v104
    v_add_f32 v121, v89, v105
    v_add_f32 v122, v90, v106
    v_add_f32 v123, v91, v107
L_pP_done:
    v_add_f32 v108, v108, v116
    v_add_f32 v109, v109, v117
    v_add_f32 v110, v110, v118
    v_add_f32 v111, v111, v119
    v_add_f32 v112, v112, v120
    v_add_f32 v113, v113, v121
    v_add_f32 v114, v114, v122
    v_add_f32 v115, v115, v123
    v_add_f32 v108, v108, v112
    v_add_f32 v109, v109, v113
    v_add_f32 v110, v110, v114
    v_add_f32 v111, v111, v115
    s_nop 0
    v_permlane32_swap_b32 v108, v110
    v_permlane32_swap_b32 v109, v111
    v_add_f32 v108, v108, v110
    v_add_f32 v109, v109, v111
    v_mov_b32 v110, v108
    v_mov_b32 v111, v109
    s_nop 0
    v_permlane16_swap_b32 v108, v110
    v_permlane16_swap_b32 v109, v111
    v_add_f32 v108, v108, v110
    v_add_f32 v109, v109, v111
    v_cvt_pk_bf16_f32 v108, v108, v109
    v_and_b32 v109, 0xffff0000, v108
    v_lshlrev_b32 v108, 16, v108
    v_add_f32 v108, v108, v50
    v_add_f32 v109, v109, v51
    v_cvt_pk_bf16_f32 v108, v108, v109
    s_mov_b32 exec_lo, 0xffff
    s_mov_b32 exec_hi, 0xffff
    v_min_u32 v108, -2, v108
    buffer_store_dword v108, v69, s[32:35], 0 offen sc1
    s_branch L_fin
L_s4:
    v_lshlrev_b32 v60, 5, v60
    v_lshl_add_u32 v60, v61, 3, v60
    s_mul_i32 s58, s3, 14336
    s_add_u32 s58, s58, 24576
    v_add_u32 v60, s58, v60
    v_lshrrev_b32 v49, 1, v27
    v_lshlrev_b32 v49, 7, v49
    v_and_b32 v50, 1, v27
    v_lshl_add_u32 v49, v50, 6, v49
    v_lshl_add_u32 v49, v74, 3, v49
    s_lshr_b32 s58, s89, 1
    s_lshl_b32 s58, s58, 9
    s_and_b32 s92, s89, 1
    s_lshl_b32 s92, s92, 5
    s_add_u32 s58, s58, s92
    s_add_u32 s58, s58, 524288
    v_add_u32 v49, s58, v49
    v_lshlrev_b32 v50, 10, v27
    v_lshl_add_u32 v50, v74, 3, v50
    s_lshl_b32 s58, s89, 5
    v_add_u32 v50, s58, v50
    s_mul_i32 s59, s3, 7168
    s_add_u32 s59, s59, 532480
    s_add_u32 s92, s59, 4096
    v_lshlrev_b32 v62, 4, v1
    s_waitcnt vmcnt(12)
    ds_read_b64_tr_b16 v[128:129], v60 offset:0
    ds_read_b64_tr_b16 v[130:131], v60 offset:128
    ds_read_b64_tr_b16 v[132:133], v60 offset:256
    ds_read_b64_tr_b16 v[134:135], v60 offset:384
    s_waitcnt vmcnt(10)
    ds_read_b64_tr_b16 v[136:137], v60 offset:2048
    ds_read_b64_tr_b16 v[138:139], v60 offset:2176
    ds_read_b64_tr_b16 v[140:141], v60 offset:2304
    ds_read_b64_tr_b16 v[142:143], v60 offset:2432
    s_waitcnt vmcnt(8)
    ds_read_b64_tr_b16 v[144:145], v60 offset:4096
    ds_read_b64_tr_b16 v[146:147], v60 offset:4224
    ds_read_b64_tr_b16 v[148:149], v60 offset:4352
    ds_read_b64_tr_b16 v[150:151], v60 offset:4480
    s_waitcnt lgkmcnt(4)
    s_waitcnt vmcnt(6)
    ds_read_b64_tr_b16 v[152:153], v60 offset:6144
    ds_read_b64_tr_b16 v[154:155], v60 offset:6272
    ds_read_b64_tr_b16 v[156:157], v60 offset:6400
    ds_read_b64_tr_b16 v[158:159], v60 offset:6528
    s_waitcnt vmcnt(4)
    ds_read_b64_tr_b16 v[160:161], v60 offset:8192
    ds_read_b64_tr_b16 v[162:163], v60 offset:8320
    ds_read_b64_tr_b16 v[164:165], v60 offset:8448
    ds_read_b64_tr_b16 v[166:167], v60 offset:8576
    s_waitcnt vmcnt(2)
    ds_read_b64_tr_b16 v[168:169], v60 offset:10240
    ds_read_b64_tr_b16 v[170:171], v60 offset:10368
    ds_read_b64_tr_b16 v[172:173], v60 offset:10496
    ds_read_b64_tr_b16 v[174:175], v60 offset:10624
    s_waitcnt lgkmcnt(4)
    s_waitcnt vmcnt(0)
    ds_read_b64_tr_b16 v[176:177], v60 offset:12288
    ds_read_b64_tr_b16 v[178:179], v60 offset:12416
    ds_read_b64_tr_b16 v[180:181], v60 offset:12544
    ds_read_b64_tr_b16 v[182:183], v60 offset:12672
    s_waitcnt lgkmcnt(0)
    s_mov_b32 s88, 200000
L_pG:
    buffer_load_dwordx4 v[76:79], v62, s[32:35], s59 offen offset:0 sc1
    buffer_load_dwordx4 v[80:83], v62, s[32:35], s59 offen offset:1024 sc1
    buffer_load_dwordx4 v[84:87], v62, s[32:35], s59 offen offset:2048 sc1
    buffer_load_dwordx4 v[88:91], v62, s[32:35], s59 offen offset:3072 sc1
    buffer_load_dwordx4 v[92:95], v62, s[32:35], s92 offen offset:0 sc1
    buffer_load_dwordx4 v[96:99], v62, s[32:35], s92 offen offset:1024 sc1
    buffer_load_dwordx4 v[100:103], v62, s[32:35], s92 offen offset:2048 sc1
    buffer_load_dwordx2 v[104:105], v49, s[32:35], 0 offen sc1
    s_waitcnt vmcnt(0)
    v_max3_u32 v48, v76, v77, v78
    v_max3_u32 v48, v48, v79, v80
    v_max3_u32 v48, v48, v81, v82
    v_max3_u32 v48, v48, v83, v84
    v_max3_u32 v48, v48, v85, v86
    v_max3_u32 v48, v48, v87, v88
    v_max3_u32 v48, v48, v89, v90
    v_max3_u32 v48, v48, v91, v92
    v_max3_u32 v48, v48, v93, v94
    v_max3_u32 v48, v48, v95, v96
    v_max3_u32 v48, v48, v97, v98
    v_max3_u32 v48, v48, v99, v100
    v_max3_u32 v48, v48, v101, v102
    v_max3_u32 v48, v48, v103, v104
    v_max_u32 v48, v48, v105
    v_cmp_eq_u32 vcc, -1, v48
    s_cbranch_vccz L_pG_A
    s_sub_u32 s88, s88, 1
    s_cbranch_scc0 L_pG
L_pG_A:
    v_mfma_f32_16x16x32_bf16 v[108:111], v[128:131], v[76:79], 0
    v_mfma_f32_16x16x32_bf16 v[112:115], v[132:135], v[76:79], 0
    v_mfma_f32_16x16x32_bf16 v[108:111], v[136:139], v[80:83], v[108:111]
    v_mfma_f32_16x16x32_bf16 v[112:115], v[140:143], v[80:83], v[112:115]
    v_mfma_f32_16x16x32_bf16 v[108:111], v[144:147], v[84:87], v[108:111]
    v_mfma_f32_16x16x32_bf16 v[112:115], v[148:151], v[84:87], v[112:115]
    v_mfma_f32_16x16x32_bf16 v[108:111], v[152:155], v[88:91], v[108:111]
    v_mfma_f32_16x16x32_bf16 v[112:115], v[156:159], v[88:91], v[112:115]
    v_mfma_f32_16x16x32_bf16 v[108:111], v[160:163], v[92:95], v[108:111]
    v_mfma_f32_16x16x32_bf16 v[112:115], v[164:167], v[92:95], v[112:115]
    v_mfma_f32_16x16x32_bf16 v[108:111], v[168:171], v[96:99], v[108:111]
    v_mfma_f32_16x16x32_bf16 v[112:115], v[172:175], v[96:99], v[112:115]
    v_mfma_f32_16x16x32_bf16 v[108:111], v[176:179], v[100:103], v[108:111]
    v_mfma_f32_16x16x32_bf16 v[112:115], v[180:183], v[100:103], v[112:115]
    v_lshlrev_b32 v116, 16, v104
    v_and_b32 v117, 0xffff0000, v104
    v_lshlrev_b32 v118, 16, v105
    v_and_b32 v119, 0xffff0000, v105
    s_nop 3
    v_add_f32_dpp v108, v112, v108 row_ror:8 row_mask:0xf bank_mask:0xf
    v_add_f32_dpp v109, v113, v109 row_ror:8 row_mask:0xf bank_mask:0xf
    v_add_f32_dpp v110, v114, v110 row_ror:8 row_mask:0xf bank_mask:0xf
    v_add_f32_dpp v111, v115, v111 row_ror:8 row_mask:0xf bank_mask:0xf
    s_mov_b32 exec_lo, 0x00ff00ff
    s_mov_b32 exec_hi, 0x00ff00ff
    ds_write_b128 v26, v[108:111] offset:4608
    s_waitcnt lgkmcnt(0)
    s_barrier
    s_cmp_eq_u32 s3, 3
    s_cbranch_scc0 L_fin
    ds_read_b128 v[128:131], v63 offset:4608
    ds_read_b128 v[132:135], v63 offset:5120
    ds_read_b128 v[136:139], v63 offset:5632
    ds_read_b128 v[140:143], v63 offset:6144
    s_waitcnt lgkmcnt(0)
    v_add_f32 v128, v128, v132
    v_add_f32 v136, v136, v140
    v_add_f32 v129, v129, v133
    v_add_f32 v137, v137, v141
    v_add_f32 v130, v130, v134
    v_add_f32 v138, v138, v142
    v_add_f32 v131, v131, v135
    v_add_f32 v139, v139, v143
    v_add_f32 v128, v128, v136
    v_add_f32 v129, v129, v137
    v_add_f32 v130, v130, v138
    v_add_f32 v131, v131, v139
    v_cvt_pk_bf16_f32 v132, v128, v129
    v_cvt_pk_bf16_f32 v133, v130, v131
    v_lshlrev_b32 v128, 16, v132
    v_and_b32 v129, 0xffff0000, v132
    v_lshlrev_b32 v130, 16, v133
    v_and_b32 v131, 0xffff0000, v133
    v_add_f32 v128, v128, v116
    v_add_f32 v129, v129, v117
    v_add_f32 v130, v130, v118
    v_add_f32 v131, v131, v119
    v_cvt_pk_bf16_f32 v132, v128, v129
    v_cvt_pk_bf16_f32 v133, v130, v131
    buffer_store_dwordx2 v[132:133], v50, s[36:39], 0 offen
L_fin:
L_end:
    s_endpgm
.section .rodata,"a"
.p2align 6
.amdhsa_kernel sequential_preLN__mha_block_cached__glu_gated_reglu__decode_kernel
  .amdhsa_next_free_vgpr 392
  .amdhsa_next_free_sgpr 102
  .amdhsa_accum_offset 256
  .amdhsa_group_segment_fixed_size 0
  .amdhsa_kernarg_size 96
  .amdhsa_user_sgpr_count 2
  .amdhsa_user_sgpr_kernarg_segment_ptr 1
  .amdhsa_system_sgpr_workgroup_id_x 1
.end_amdhsa_kernel
```
